```python
import torch

def _softmax(x, axis=-1):
    return torch.softmax(x, dim=axis)
def _gelu(x):
    return torch.nn.functional.gelu(x, approximate="tanh")
def _silu(x):
    return torch.nn.functional.silu(x)
def _sigmoid(x):
    return torch.sigmoid(x)
def _layernorm(x, axis=-1, eps=1e-5):
    m = x.mean(dim=axis, keepdim=True)
    v = x.var(dim=axis, keepdim=True, unbiased=False)
    return (x - m) / torch.sqrt(v + eps)
def _scatter_add(tgt, idx, src, axis=0):
    return tgt.clone().index_add_(axis, idx, src)
def _segment_sum(src, seg, n):
    out = torch.zeros((n,) + src.shape[1:], dtype=src.dtype)
    return out.index_add_(0, seg, src)
def _pad(x, pw):
    flat = tuple(v for pair in reversed(pw) for v in pair)
    return torch.nn.functional.pad(x, flat)

kernel_name = 'gated_mix__ssm_conv_s5__linear_kernel_hedgehog__prompt'

def setup_inputs():

    _w = (lambda a: (lambda t: t.to(torch.bfloat16) if t.is_floating_point() else t)(torch.as_tensor(a)))
    def _A_setup():
        B, S, D = 1, 2048, 512
        P = D
        Lambda_re = -0.5 * (lambda _x: torch.exp(torch.as_tensor(_x)))((lambda *s: torch.randn(*s, dtype=torch.bfloat16) * 0.8)(P))
        Lambda_im = (lambda *s: torch.randn(*s, dtype=torch.bfloat16) * 0.8)(P) * 1.0
        B_re = (lambda *s: torch.randn(*s, dtype=torch.bfloat16) * 0.8)(P, D) * (D ** -0.5)
        B_im = (lambda *s: torch.randn(*s, dtype=torch.bfloat16) * 0.8)(P, D) * (D ** -0.5)
        C_re = (lambda *s: torch.randn(*s, dtype=torch.bfloat16) * 0.8)(D, P) * (P ** -0.5)
        C_im = (lambda *s: torch.randn(*s, dtype=torch.bfloat16) * 0.8)(D, P) * (P ** -0.5)
        log_dt = (lambda *s: torch.randn(*s, dtype=torch.bfloat16) * 0.8)(P) * 0.3 - 2.0
        Dskip = (lambda *s: torch.randn(*s, dtype=torch.bfloat16) * 0.8)(D)
        return {
            "x": _w((lambda *s: torch.randn(*s, dtype=torch.bfloat16) * 0.05)(B, S, D)),
            "Lambda_re": _w(Lambda_re),
            "Lambda_im": _w(Lambda_im),
            "B_re": _w(B_re),
            "B_im": _w(B_im),
            "C_re": _w(C_re),
            "C_im": _w(C_im),
            "log_dt": _w(log_dt),
            "Dskip": _w(Dskip),
        }
    _A_in = _A_setup()

    def _B_setup():
        B, S, D, H = 1, 2048, 512, 32
        Dh = D // H
        return {
            "x": _w((lambda *s: torch.randn(*s, dtype=torch.bfloat16) * 0.05)(B, S, D)),
            "wqkv": _w((lambda *s: torch.randn(*s, dtype=torch.bfloat16) * 1.6)(D, 3 * D)),
            "w_phi": _w((lambda *s: torch.randn(*s, dtype=torch.bfloat16) * 1.6)(H, Dh, Dh) * (Dh ** -0.5)),
            "wo": _w((lambda *s: torch.randn(*s, dtype=torch.bfloat16) * 0.05)(D, D)),
        }
    _B_in = _B_setup()

    return {
        "A_x": _A_in["x"],
        "A_Lambda_re": _A_in["Lambda_re"],
        "A_Lambda_im": _A_in["Lambda_im"],
        "A_B_re": _A_in["B_re"],
        "A_B_im": _A_in["B_im"],
        "A_C_re": _A_in["C_re"],
        "A_C_im": _A_in["C_im"],
        "A_log_dt": _A_in["log_dt"],
        "A_Dskip": _A_in["Dskip"],
        "B_x": _B_in["x"],
        "B_wqkv": _B_in["wqkv"],
        "B_w_phi": _B_in["w_phi"],
        "B_wo": _B_in["wo"],
        "gate_w": _w((lambda *s: torch.randn(*s, dtype=torch.bfloat16) * 0.05)(512) * 16.0),
    }

def reference(A_x, A_Lambda_re, A_Lambda_im, A_B_re, A_B_im, A_C_re, A_C_im, A_log_dt, A_Dskip, B_x, B_wqkv, B_w_phi, B_wo, gate_w):
    def _A_ref(x, Lambda_re, Lambda_im, B_re, B_im, C_re, C_im, log_dt, Dskip):
        Bsz, L, H = x.shape
        Lam = Lambda_re + 1j * Lambda_im
        Bmat = B_re + 1j * B_im
        Cmat = C_re + 1j * C_im
        dt = torch.exp(log_dt)
        Lam_bar = torch.exp(dt * Lam)
        B_bar = ((Lam_bar - 1.0) / Lam)[:, None] * Bmat
        Bu = torch.einsum("bld,pd->blp", x + 0j, B_bar)
        h = torch.zeros_like(Bu[:, 0, :])
        hs = []
        for t in range(L):
            h = Lam_bar[None, :] * h + Bu[:, t, :]
            hs.append(h)
        hseq = torch.stack(hs, 1)
        y = 2.0 * torch.einsum("blp,dp->bld", hseq, Cmat).real + x * Dskip[None, None, :]
        return y

    def _B_ref(x, wqkv, w_phi, wo):
        B, S, D = x.shape
        H = 32; Dh = D // H
        qkv = (lambda x, *d: x.permute(*d))((x @ wqkv).reshape(B, S, 3, H, Dh), 2, 0, 3, 1, 4)
        q, k, v = qkv[0], qkv[1], qkv[2]
        pq = torch.einsum("bhsd,hdf->bhsf", q, w_phi)
        pk = torch.einsum("bhsd,hdf->bhsf", k, w_phi)
        phi_q = torch.concatenate([_softmax(pq, axis=-1), _softmax(-pq, axis=-1)], axis=-1)
        phi_k = torch.concatenate([_softmax(pk, axis=-1), _softmax(-pk, axis=-1)], axis=-1)
        kv = torch.einsum("bhsf,bhsd->bhfd", phi_k, v)
        z  = torch.einsum("bhsf->bhf", phi_k)
        num = torch.einsum("bhqf,bhfd->bhqd", phi_q, kv)
        den = torch.einsum("bhqf,bhf->bhq", phi_q, z)[..., None] + 1e-6
        o = num / den
        return (lambda x, *d: x.permute(*d))(o, 0, 2, 1, 3).reshape(B, S, D) @ wo

    x = A_x
    g = _sigmoid((x * gate_w).sum(-1, keepdims=True))
    a = _A_ref(x, A_Lambda_re, A_Lambda_im, A_B_re, A_B_im, A_C_re, A_C_im, A_log_dt, A_Dskip)
    b = _B_ref(x, B_wqkv, B_w_phi, B_wo)
    return g * a + (1 - g) * b
```

```asm
; @launch grid=(256,1,1) block=(512,1,1) lds=163840
.amdgcn_target "amdgcn-amd-amdhsa--gfx950"
.text
.globl gated_mix__ssm_conv_s5__linear_kernel_hedgehog__prompt_kernel
.p2align 12
.p2align 8
.type gated_mix__ssm_conv_s5__linear_kernel_hedgehog__prompt_kernel,@function
gated_mix__ssm_conv_s5__linear_kernel_hedgehog__prompt_kernel:
    s_cmp_ge_u32 s2, 256
    s_cbranch_scc1 L_end
    s_load_dwordx16 s[36:51], s[0:1], 0
    s_load_dwordx16 s[52:67], s[0:1], 64
    s_load_dwordx2 s[68:69], s[0:1], 128
    v_lshrrev_b32 v1, 6, v0
    v_and_b32 v0, 63, v0
    v_readfirstlane_b32 s3, v1
    s_and_b32 s94, s2, 3
    s_lshl_b32 s94, s94, 2
    s_bfe_u32 s88, s2, 0x20003
    s_add_u32 s88, s88, s94
    s_and_b32 s94, s2, 4
    s_lshl_b32 s94, s94, 1
    s_lshr_b32 s89, s2, 5
    s_add_u32 s89, s89, s94
    s_and_b32 s90, s3, 3
    s_mul_i32 s91, s89, 1
    s_mul_i32 s94, s88, 2
    s_add_u32 s91, s91, s94
    s_lshr_b32 s94, s88, 2
    s_mul_i32 s94, s94, 1
    s_add_u32 s91, s91, s94
    s_and_b32 s91, s91, 7
    v_lshlrev_b32 v3, 4, v0
    s_lshl_b32 s98, s90, 12
    s_add_u32 s98, s98, 32768
    s_cmp_lt_u32 s3, 4
    s_cbranch_scc1 L_roleT
L_roleS:
    s_setprio 2
    s_getpc_b64 s[70:71]
L_pc:
    s_sub_u32 s70, s70, L_pc-gated_mix__ssm_conv_s5__linear_kernel_hedgehog__prompt_kernel
    s_subb_u32 s71, s71, 0
    s_lshr_b32 s94, s2, 3
    s_lshl_b32 s94, s94, 2
    s_add_u32 s94, s94, s90
    s_lshl_b32 s94, s94, 8
    v_lshl_add_u32 v98, v0, 7, s94
    v_min_u32 v98, L_codeend-4-gated_mix__ssm_conv_s5__linear_kernel_hedgehog__prompt_kernel, v98
    s_mov_b64 exec, 3
    global_load_dword v99, v98, s[70:71]
    s_mov_b64 exec, -1
    v_and_b32 v96, 19, v0
    v_bfe_u32 v97, v0, 2, 1
    v_lshl_add_u32 v96, v97, 3, v96
    v_bfe_u32 v97, v0, 3, 1
    v_lshl_add_u32 v96, v97, 2, v96
    s_lshl_b32 s94, s89, 5
    v_add_u32 v96, s94, v96
    v_lshlrev_b32 v96, 1, v96
    s_lshl_b32 s94, s91, 3
    s_bitcmp1_b32 s90, 0
    s_cselect_b32 s94, 0, s94
    s_cselect_b32 s95, 1024, 0
    s_add_u32 m0, s95, 132096
    v_add_u32 v97, s94, v0
    v_and_b32 v97, 63, v97
    v_lshlrev_b32 v97, 4, v97
    s_mov_b32 s6, 1024
    s_mov_b32 s7, 0x20000
    s_lshl_b32 s95, s89, 10
    v_and_b32 v104, 31, v0
    v_lshlrev_b32 v6, 7, v104
    v_bfe_u32 v104, v0, 1, 3
    v_lshrrev_b32 v105, 5, v0
    v_xor_b32 v104, v104, v105
    v_lshl_add_u32 v6, v104, 4, v6
    v_add_u32 v6, 139264, v6
    v_xor_b32 v7, 32, v6
    v_xor_b32 v8, 64, v6
    v_xor_b32 v9, 96, v6
    s_sub_u32 s94, s98, 139264
    v_add_u32 v12, s94, v6
    v_add_u32 v13, s94, v7
    v_add_u32 v14, s94, v8
    v_add_u32 v15, s94, v9
    v_mov_b32 v114, 0
    s_waitcnt lgkmcnt(0)
    s_add_u32 s4, s58, s95
    s_addc_u32 s5, s59, 0
    s_bitcmp1_b32 s90, 0
    s_cselect_b64 s[4:5], s[4:5], s[62:63]
    global_load_ushort v100, v96, s[50:51]
    global_load_ushort v101, v96, s[38:39]
    global_load_ushort v102, v96, s[40:41]
    global_load_dword v114, v114, s[68:69] sc1
    s_cmp_ge_u32 s90, 2
    s_cbranch_scc1 L_s1
    buffer_load_dwordx4 v97, s[4:7], 0 offen lds
L_s1:
    s_branch L_role_Smain
L_roleT:
    s_add_u32 s94, s91, 0
    s_and_b32 s94, s94, 7
    s_lshl_b32 s70, s94, 7
    s_mul_i32 s78, s94, 196608
    s_add_u32 s94, s91, 1
    s_and_b32 s94, s94, 7
    s_lshl_b32 s71, s94, 7
    s_mul_i32 s79, s94, 196608
    v_lshrrev_b32 v32, 5, v0
    v_bfe_u32 v33, v0, 3, 2
    v_and_b32 v34, 7, v0
    v_lshrrev_b32 v35, 4, v0
    v_xor_b32 v34, v34, v35
    v_lshlrev_b32 v34, 4, v34
    v_lshl_add_u32 v36, v32, 4, v33
    v_lshl_add_u32 v6, v36, 10, v34
    v_xor_b32 v7, 64, v6
    v_add_u32 v8, 6144, v6
    v_add_u32 v9, 9216, v7
    v_add_u32 v7, 3072, v7
    v_lshl_add_u32 v36, v32, 3, v33
    v_lshl_add_u32 v5, v36, 10, v34
    s_and_b32 s94, s90, 1
    s_lshl_b32 s95, s94, 6
    v_xor_b32 v5, s95, v5
    s_lshl_b32 s94, s94, 12
    s_lshr_b32 s95, s90, 1
    s_lshl_b32 s95, s95, 14
    s_add_u32 s94, s94, s95
    s_lshl_b32 s95, s89, 15
    s_add_u32 s96, s94, s95
    s_lshl_b32 s94, s88, 17
    s_lshl_b32 s95, s90, 15
    s_add_u32 s97, s94, s95
    s_lshl_b32 s93, s90, 10
    v_lshrrev_b32 v36, 2, v0
    v_mul_u32_u24 v36, 3072, v36
    v_and_b32 v37, 3, v0
    v_lshl_add_u32 v10, v37, 4, v36
    s_mul_i32 s94, s90, 49152
    s_lshl_b32 s95, s89, 6
    s_add_u32 s94, s94, s95
    s_add_u32 s99, s94, 1024
    s_sub_u32 s6, 2097152, s97
    s_mov_b32 s7, 0x20000
    s_sub_u32 s10, 524288, s96
    s_mov_b32 s11, 0x20000
    s_sub_u32 s14, 524288, s96
    s_mov_b32 s15, 0x20000
    s_sub_u32 s18, 1572864, s99
    s_mov_b32 s19, 0x20000
    s_add_u32 m0, s98, 32768
    s_waitcnt lgkmcnt(0)
    s_add_u32 s4, s36, s97
    s_addc_u32 s5, s37, 0
    buffer_load_dwordx4 v6, s[4:7], s70 offen offset:0 lds
    buffer_load_dwordx4 v7, s[4:7], s70 offen offset:1024 lds
    buffer_load_dwordx4 v8, s[4:7], s70 offen offset:2048 lds
    buffer_load_dwordx4 v9, s[4:7], s70 offen offset:3072 lds
    s_add_u32 s8, s42, s96
    s_addc_u32 s9, s43, 0
    s_add_u32 s12, s44, s96
    s_addc_u32 s13, s45, 0
    s_add_u32 m0, s93, 139264
    s_nop 0
    buffer_load_dwordx4 v5, s[8:11], s70 offen lds
    s_add_u32 m0, s93, 143360
    s_nop 0
    buffer_load_dwordx4 v5, s[12:15], s70 offen lds
    s_add_u32 s16, s56, s99
    s_addc_u32 s17, s57, 0
    s_add_u32 m0, s93, 0
    s_nop 0
    buffer_load_dwordx4 v10, s[16:19], s78 offen lds
    s_add_u32 m0, s98, 49152
    s_nop 0
    buffer_load_dwordx4 v6, s[4:7], s71 offen offset:0 lds
    buffer_load_dwordx4 v7, s[4:7], s71 offen offset:1024 lds
    s_add_u32 s94, s91, 2
    s_and_b32 s94, s94, 7
    s_lshl_b32 s72, s94, 7
    s_mul_i32 s80, s94, 196608
    s_add_u32 s94, s91, 3
    s_and_b32 s94, s94, 7
    s_lshl_b32 s73, s94, 7
    s_mul_i32 s81, s94, 196608
    s_add_u32 s94, s91, 4
    s_and_b32 s94, s94, 7
    s_lshl_b32 s74, s94, 7
    s_mul_i32 s82, s94, 196608
    s_add_u32 s94, s91, 5
    s_and_b32 s94, s94, 7
    s_lshl_b32 s75, s94, 7
    s_mul_i32 s83, s94, 196608
    s_add_u32 s94, s91, 6
    s_and_b32 s94, s94, 7
    s_lshl_b32 s76, s94, 7
    s_mul_i32 s84, s94, 196608
    s_add_u32 s94, s91, 7
    s_and_b32 s94, s94, 7
    s_lshl_b32 s77, s94, 7
    s_mul_i32 s85, s94, 196608
    v_add_u32 v113, 132096, v34
    v_and_b32 v32, 31, v0
    v_lshlrev_b32 v12, 7, v32
    v_bfe_u32 v32, v0, 1, 3
    v_lshrrev_b32 v33, 5, v0
    v_xor_b32 v32, v32, v33
    v_lshl_add_u32 v12, v32, 4, v12
    v_add_u32 v12, s98, v12
    v_xor_b32 v13, 32, v12
    v_xor_b32 v14, 64, v12
    v_xor_b32 v15, 96, v12
    v_lshrrev_b32 v32, 5, v0
    v_bfe_u32 v33, v0, 2, 2
    v_lshl_add_u32 v32, v32, 3, v33
    v_bfe_u32 v34, v0, 4, 1
    v_lshlrev_b32 v11, 6, v32
    v_lshl_add_u32 v11, v34, 5, v11
    v_and_b32 v35, 1, v0
    v_lshl_add_u32 v11, v35, 4, v11
    v_bfe_u32 v35, v0, 1, 1
    v_lshl_add_u32 v11, v35, 3, v11
    v_lshlrev_b32 v112, 5, v32
    v_lshl_add_u32 v112, v34, 4, v112
    v_lshl_add_u32 v112, v35, 3, v112
    v_add_u32 v112, 133120, v112
    s_lshr_b32 s94, s89, 3
    s_lshl_b32 s94, s94, 13
    s_lshl_b32 s95, s90, 11
    s_add_u32 s94, s94, s95
    s_add_u32 s94, s94, 32768
    v_add_u32 v115, s94, v3
    v_xor_b32 v116, 64, v115
    v_mov_b32 v118, 0
    v_mov_b32 v119, 0
    s_sub_u32 s94, s99, 1024
    s_add_u32 s24, s56, s94
    s_addc_u32 s25, s57, 0
    s_sub_u32 s26, 1572864, s94
    s_mov_b32 s27, 0x20000
    s_add_u32 s94, s99, 1024
    s_add_u32 s20, s56, s94
    s_addc_u32 s21, s57, 0
    s_sub_u32 s22, 1572864, s94
    s_mov_b32 s23, 0x20000
    s_mov_b32 s28, s68
    s_mov_b32 s29, s69
    s_mov_b32 s30, 16777216
    s_mov_b32 s31, 0x20000
    s_lshl_b32 s94, s3, 2
    s_add_u32 s94, s94, 131072
    v_mov_b32 v1, s94
    s_and_b32 s94, s94, 0xfffffff0
    v_mov_b32 v2, s94
    v_bfe_u32 v32, v0, 3, 2
    v_and_b32 v33, 3, v0
    v_lshl_add_u32 v32, v32, 2, v33
    v_bfe_u32 v33, v0, 2, 1
    v_lshrrev_b32 v34, 5, v0
    v_xor_b32 v33, v33, v34
    v_lshl_add_u32 v32, v33, 4, v32
    v_and_b32 v33, 1, v0
    v_lshlrev_b32 v33, 4, v33
    v_mov_b32 v34, 0x3f80
    v_lshlrev_b32 v33, v33, v34
    v_lshrrev_b32 v32, 1, v32
    v_cmp_eq_u32 vcc, 0, v32
    s_nop 1
    v_cndmask_b32 v24, 0, v33, vcc
    v_cmp_eq_u32 vcc, 1, v32
    s_nop 1
    v_cndmask_b32 v25, 0, v33, vcc
    v_cmp_eq_u32 vcc, 2, v32
    s_nop 1
    v_cndmask_b32 v26, 0, v33, vcc
    v_cmp_eq_u32 vcc, 3, v32
    s_nop 1
    v_cndmask_b32 v27, 0, v33, vcc
    v_cmp_eq_u32 vcc, 4, v32
    s_nop 1
    v_cndmask_b32 v28, 0, v33, vcc
    v_cmp_eq_u32 vcc, 5, v32
    s_nop 1
    v_cndmask_b32 v29, 0, v33, vcc
    v_cmp_eq_u32 vcc, 6, v32
    s_nop 1
    v_cndmask_b32 v30, 0, v33, vcc
    v_cmp_eq_u32 vcc, 7, v32
    s_nop 1
    v_cndmask_b32 v31, 0, v33, vcc
    v_mov_b32 v32, 0
    s_mov_b64 exec, 1
    ds_write_b32 v1, v32
    s_mov_b64 exec, -1
    s_mov_b32 s96, 1069066811
    s_mov_b32 s97, 3216550459
    buffer_load_dwordx4 v8, s[4:7], s71 offen offset:2048 lds
    buffer_load_dwordx4 v9, s[4:7], s71 offen offset:3072 lds
    s_add_u32 m0, s93, 147456
    s_nop 0
    buffer_load_dwordx4 v5, s[8:11], s71 offen lds
    s_add_u32 m0, s93, 151552
    s_nop 0
    buffer_load_dwordx4 v5, s[12:15], s71 offen lds
    s_add_u32 m0, s93, 4096
    s_nop 0
    buffer_load_dwordx4 v10, s[16:19], s79 offen lds
    s_waitcnt vmcnt(7)
    s_waitcnt lgkmcnt(0)
    s_barrier
    s_add_u32 m0, s98, 0
    s_nop 0
    buffer_load_dwordx4 v6, s[4:7], s72 offen offset:0 lds
    buffer_load_dwordx4 v7, s[4:7], s72 offen offset:1024 lds
    buffer_load_dwordx4 v8, s[4:7], s72 offen offset:2048 lds
    buffer_load_dwordx4 v9, s[4:7], s72 offen offset:3072 lds
    s_add_u32 m0, s93, 155648
    s_nop 0
    buffer_load_dwordx4 v5, s[8:11], s72 offen lds
    s_add_u32 m0, s93, 159744
    s_nop 0
    buffer_load_dwordx4 v5, s[12:15], s72 offen lds
    s_add_u32 m0, s93, 8192
    s_nop 0
    buffer_load_dwordx4 v10, s[16:19], s80 offen lds
    v_mov_b32 v114, 0
    global_load_dword v114, v114, s[68:69] sc1
    ds_read_b128 v[128:131], v12 offset:32768
    ds_read_b64_tr_b16 v[80:81], v11 offset:0
    ds_read_b64_tr_b16 v[82:83], v11 offset:256
    ds_read_b128 v[132:135], v13 offset:32768
    ds_read_b64_tr_b16 v[84:85], v11 offset:1024
    ds_read_b64_tr_b16 v[86:87], v11 offset:1280
    ds_read_b128 v[136:139], v14 offset:32768
    ds_read_b64_tr_b16 v[88:89], v11 offset:2048
    ds_read_b64_tr_b16 v[90:91], v11 offset:2304
    ds_read_b128 v[140:143], v15 offset:32768
    ds_read_b64_tr_b16 v[92:93], v11 offset:3072
    ds_read_b64_tr_b16 v[94:95], v11 offset:3328
    s_waitcnt vmcnt(8)
    s_waitcnt lgkmcnt(0)
    s_barrier
    s_add_u32 m0, s98, 16384
    s_nop 0
    buffer_load_dwordx4 v6, s[4:7], s73 offen offset:0 lds
    buffer_load_dwordx4 v7, s[4:7], s73 offen offset:1024 lds
    buffer_load_dwordx4 v8, s[4:7], s73 offen offset:2048 lds
    buffer_load_dwordx4 v9, s[4:7], s73 offen offset:3072 lds
    s_add_u32 m0, s93, 139264
    s_nop 0
    buffer_load_dwordx4 v5, s[8:11], s73 offen lds
    s_add_u32 m0, s93, 143360
    s_nop 0
    buffer_load_dwordx4 v5, s[12:15], s73 offen lds
    s_add_u32 m0, s93, 12288
    s_nop 0
    buffer_load_dwordx4 v10, s[16:19], s81 offen lds
    v_mfma_f32_32x32x16_bf16 v[32:47], v[80:83], v[128:131], 0
    ds_read_b128 v[144:147], v12 offset:49152
    ds_read_b64_tr_b16 v[96:97], v11 offset:4096
    ds_read_b64_tr_b16 v[98:99], v11 offset:4352
    v_mfma_f32_32x32x16_bf16 v[32:47], v[84:87], v[132:135], v[32:47]
    ds_read_b128 v[148:151], v13 offset:49152
    ds_read_b64_tr_b16 v[100:101], v11 offset:5120
    ds_read_b64_tr_b16 v[102:103], v11 offset:5376
    v_mfma_f32_32x32x16_bf16 v[32:47], v[88:91], v[136:139], v[32:47]
    ds_read_b128 v[152:155], v14 offset:49152
    ds_read_b64_tr_b16 v[104:105], v11 offset:6144
    ds_read_b64_tr_b16 v[106:107], v11 offset:6400
    v_mfma_f32_32x32x16_bf16 v[32:47], v[92:95], v[140:143], v[32:47]
    ds_read_b128 v[156:159], v15 offset:49152
    ds_read_b64_tr_b16 v[108:109], v11 offset:7168
    ds_read_b64_tr_b16 v[110:111], v11 offset:7424
    ds_read_b128 v[48:51], v115 offset:32768
    ds_read_b128 v[52:55], v116 offset:33792
    ds_read_b128 v[56:59], v113 offset:0
    s_waitcnt vmcnt(8)
    s_waitcnt lgkmcnt(0)
    s_barrier
    s_add_u32 m0, s98, 32768
    s_nop 0
    buffer_load_dwordx4 v6, s[4:7], s74 offen offset:0 lds
    buffer_load_dwordx4 v7, s[4:7], s74 offen offset:1024 lds
    buffer_load_dwordx4 v8, s[4:7], s74 offen offset:2048 lds
    buffer_load_dwordx4 v9, s[4:7], s74 offen offset:3072 lds
    s_add_u32 m0, s93, 147456
    s_nop 0
    buffer_load_dwordx4 v5, s[8:11], s74 offen lds
    s_add_u32 m0, s93, 151552
    s_nop 0
    buffer_load_dwordx4 v5, s[12:15], s74 offen lds
    s_add_u32 m0, s93, 16384
    s_nop 0
    buffer_load_dwordx4 v10, s[16:19], s82 offen lds
    v_mfma_f32_32x32x16_bf16 v[32:47], v[96:99], v[144:147], v[32:47]
    ds_read_b128 v[160:163], v12 offset:0
    ds_read_b64_tr_b16 v[80:81], v11 offset:8192
    ds_read_b64_tr_b16 v[82:83], v11 offset:8448
    v_mfma_f32_32x32x16_bf16 v[32:47], v[100:103], v[148:151], v[32:47]
    ds_read_b128 v[164:167], v13 offset:0
    ds_read_b64_tr_b16 v[84:85], v11 offset:9216
    ds_read_b64_tr_b16 v[86:87], v11 offset:9472
    v_mfma_f32_32x32x16_bf16 v[32:47], v[104:107], v[152:155], v[32:47]
    ds_read_b128 v[168:171], v14 offset:0
    ds_read_b64_tr_b16 v[88:89], v11 offset:10240
    ds_read_b64_tr_b16 v[90:91], v11 offset:10496
    v_mfma_f32_32x32x16_bf16 v[32:47], v[108:111], v[156:159], v[32:47]
    ds_read_b128 v[172:175], v15 offset:0
    ds_read_b64_tr_b16 v[92:93], v11 offset:11264
    ds_read_b64_tr_b16 v[94:95], v11 offset:11520
    ds_read_b128 v[60:63], v115 offset:49152
    ds_read_b128 v[64:67], v116 offset:50176
    ds_read_b128 v[68:71], v113 offset:128
    v_dot2c_f32_bf16 v118, v48, v56
    v_dot2c_f32_bf16 v119, v52, v56
    v_dot2c_f32_bf16 v118, v49, v57
    v_dot2c_f32_bf16 v119, v53, v57
    v_dot2c_f32_bf16 v118, v50, v58
    v_dot2c_f32_bf16 v119, v54, v58
    v_dot2c_f32_bf16 v118, v51, v59
    v_dot2c_f32_bf16 v119, v55, v59
    ds_read_b64_tr_b16 v[16:17], v112 offset:0
    ds_read_b64_tr_b16 v[18:19], v112 offset:128
    ds_read_b64_tr_b16 v[20:21], v112 offset:512
    ds_read_b64_tr_b16 v[22:23], v112 offset:640
    s_waitcnt vmcnt(7)
    s_waitcnt lgkmcnt(0)
    s_barrier
    s_add_u32 m0, s98, 49152
    s_nop 0
    buffer_load_dwordx4 v6, s[4:7], s75 offen offset:0 lds
    buffer_load_dwordx4 v7, s[4:7], s75 offen offset:1024 lds
    buffer_load_dwordx4 v8, s[4:7], s75 offen offset:2048 lds
    buffer_load_dwordx4 v9, s[4:7], s75 offen offset:3072 lds
    s_add_u32 m0, s93, 155648
    s_nop 0
    buffer_load_dwordx4 v5, s[8:11], s75 offen lds
    s_add_u32 m0, s93, 159744
    s_nop 0
    buffer_load_dwordx4 v5, s[12:15], s75 offen lds
    s_add_u32 m0, s93, 20480
    s_nop 0
    buffer_load_dwordx4 v10, s[16:19], s83 offen lds
    v_mfma_f32_32x32x16_bf16 v[32:47], v[80:83], v[160:163], v[32:47]
    ds_read_b128 v[176:179], v12 offset:16384
    ds_read_b64_tr_b16 v[96:97], v11 offset:12288
    ds_read_b64_tr_b16 v[98:99], v11 offset:12544
    v_mfma_f32_32x32x16_bf16 v[32:47], v[84:87], v[164:167], v[32:47]
    ds_read_b128 v[180:183], v13 offset:16384
    ds_read_b64_tr_b16 v[100:101], v11 offset:13312
    ds_read_b64_tr_b16 v[102:103], v11 offset:13568
    v_mfma_f32_32x32x16_bf16 v[32:47], v[88:91], v[168:171], v[32:47]
    ds_read_b128 v[184:187], v14 offset:16384
    ds_read_b64_tr_b16 v[104:105], v11 offset:14336
    ds_read_b64_tr_b16 v[106:107], v11 offset:14592
    v_mfma_f32_32x32x16_bf16 v[32:47], v[92:95], v[172:175], v[32:47]
    ds_read_b128 v[188:191], v15 offset:16384
    ds_read_b64_tr_b16 v[108:109], v11 offset:15360
    ds_read_b64_tr_b16 v[110:111], v11 offset:15616
    ds_read_b128 v[48:51], v115 offset:0
    ds_read_b128 v[52:55], v116 offset:1024
    ds_read_b128 v[56:59], v113 offset:256
    v_dot2c_f32_bf16 v118, v60, v68
    v_dot2c_f32_bf16 v119, v64, v68
    v_dot2c_f32_bf16 v118, v61, v69
    v_dot2c_f32_bf16 v119, v65, v69
    v_dot2c_f32_bf16 v118, v62, v70
    v_dot2c_f32_bf16 v119, v66, v70
    v_dot2c_f32_bf16 v118, v63, v71
    v_dot2c_f32_bf16 v119, v67, v71
    v_readfirstlane_b32 s54, v114
    s_nop 0
    s_mul_i32 s86, s54, 1664525
    s_add_u32 s86, s86, 1013904223
    s_mul_i32 s87, s54, 22695477
    s_add_u32 s87, s87, 0x9e3779b9
    v_bfe_u32 v112, v0, 2, 1
    v_mul_u32_u24 v112, 0x8000, v112
    v_lshl_or_b32 v112, v112, 16, v112
    v_xor_b32 v16, v16, v112
    v_xor_b32 v17, v17, v112
    v_xor_b32 v18, v18, v112
    v_xor_b32 v19, v19, v112
    v_xor_b32 v20, v20, v112
    v_xor_b32 v21, v21, v112
    v_xor_b32 v22, v22, v112
    v_xor_b32 v23, v23, v112
    s_waitcnt vmcnt(7)
    s_waitcnt lgkmcnt(0)
    s_barrier
    s_add_u32 m0, s98, 0
    s_nop 0
    buffer_load_dwordx4 v6, s[4:7], s76 offen offset:0 lds
    buffer_load_dwordx4 v7, s[4:7], s76 offen offset:1024 lds
    buffer_load_dwordx4 v8, s[4:7], s76 offen offset:2048 lds
    buffer_load_dwordx4 v9, s[4:7], s76 offen offset:3072 lds
    s_add_u32 m0, s93, 139264
    s_nop 0
    buffer_load_dwordx4 v5, s[8:11], s76 offen lds
    s_add_u32 m0, s93, 143360
    s_nop 0
    buffer_load_dwordx4 v5, s[12:15], s76 offen lds
    s_add_u32 m0, s93, 24576
    s_nop 0
    buffer_load_dwordx4 v10, s[16:19], s84 offen lds
    v_mfma_f32_32x32x16_bf16 v[32:47], v[96:99], v[176:179], v[32:47]
    ds_read_b128 v[192:195], v12 offset:32768
    ds_read_b64_tr_b16 v[80:81], v11 offset:16384
    ds_read_b64_tr_b16 v[82:83], v11 offset:16640
    v_mfma_f32_32x32x16_bf16 v[32:47], v[100:103], v[180:183], v[32:47]
    ds_read_b128 v[196:199], v13 offset:32768
    ds_read_b64_tr_b16 v[84:85], v11 offset:17408
    ds_read_b64_tr_b16 v[86:87], v11 offset:17664
    v_mfma_f32_32x32x16_bf16 v[32:47], v[104:107], v[184:187], v[32:47]
    ds_read_b128 v[200:203], v14 offset:32768
    ds_read_b64_tr_b16 v[88:89], v11 offset:18432
    ds_read_b64_tr_b16 v[90:91], v11 offset:18688
    v_mfma_f32_32x32x16_bf16 v[32:47], v[108:111], v[188:191], v[32:47]
    ds_read_b128 v[204:207], v15 offset:32768
    ds_read_b64_tr_b16 v[92:93], v11 offset:19456
    ds_read_b64_tr_b16 v[94:95], v11 offset:19712
    ds_read_b128 v[60:63], v115 offset:16384
    ds_read_b128 v[64:67], v116 offset:17408
    ds_read_b128 v[68:71], v113 offset:384
    v_dot2c_f32_bf16 v118, v48, v56
    v_dot2c_f32_bf16 v119, v52, v56
    v_dot2c_f32_bf16 v118, v49, v57
    v_dot2c_f32_bf16 v119, v53, v57
    v_dot2c_f32_bf16 v118, v50, v58
    v_dot2c_f32_bf16 v119, v54, v58
    v_dot2c_f32_bf16 v118, v51, v59
    v_dot2c_f32_bf16 v119, v55, v59
    s_waitcnt vmcnt(7)
    s_waitcnt lgkmcnt(0)
    s_barrier
    s_add_u32 m0, s98, 16384
    s_nop 0
    buffer_load_dwordx4 v6, s[4:7], s77 offen offset:0 lds
    buffer_load_dwordx4 v7, s[4:7], s77 offen offset:1024 lds
    buffer_load_dwordx4 v8, s[4:7], s77 offen offset:2048 lds
    buffer_load_dwordx4 v9, s[4:7], s77 offen offset:3072 lds
    s_add_u32 m0, s93, 147456
    s_nop 0
    buffer_load_dwordx4 v5, s[8:11], s77 offen lds
    s_add_u32 m0, s93, 151552
    s_nop 0
    buffer_load_dwordx4 v5, s[12:15], s77 offen lds
    s_add_u32 m0, s93, 28672
    s_nop 0
    buffer_load_dwordx4 v10, s[16:19], s85 offen lds
    v_mfma_f32_32x32x16_bf16 v[32:47], v[80:83], v[192:195], v[32:47]
    ds_read_b128 v[208:211], v12 offset:49152
    ds_read_b64_tr_b16 v[96:97], v11 offset:20480
    ds_read_b64_tr_b16 v[98:99], v11 offset:20736
    v_mfma_f32_32x32x16_bf16 v[32:47], v[84:87], v[196:199], v[32:47]
    ds_read_b128 v[212:215], v13 offset:49152
    ds_read_b64_tr_b16 v[100:101], v11 offset:21504
    ds_read_b64_tr_b16 v[102:103], v11 offset:21760
    v_mfma_f32_32x32x16_bf16 v[32:47], v[88:91], v[200:203], v[32:47]
    ds_read_b128 v[216:219], v14 offset:49152
    ds_read_b64_tr_b16 v[104:105], v11 offset:22528
    ds_read_b64_tr_b16 v[106:107], v11 offset:22784
    v_mfma_f32_32x32x16_bf16 v[32:47], v[92:95], v[204:207], v[32:47]
    ds_read_b128 v[220:223], v15 offset:49152
    ds_read_b64_tr_b16 v[108:109], v11 offset:23552
    ds_read_b64_tr_b16 v[110:111], v11 offset:23808
    ds_read_b128 v[48:51], v115 offset:32768
    ds_read_b128 v[52:55], v116 offset:33792
    ds_read_b128 v[56:59], v113 offset:512
    v_dot2c_f32_bf16 v118, v60, v68
    v_dot2c_f32_bf16 v119, v64, v68
    v_dot2c_f32_bf16 v118, v61, v69
    v_dot2c_f32_bf16 v119, v65, v69
    v_dot2c_f32_bf16 v118, v62, v70
    v_dot2c_f32_bf16 v119, v66, v70
    v_dot2c_f32_bf16 v118, v63, v71
    v_dot2c_f32_bf16 v119, v67, v71
    s_waitcnt vmcnt(7)
    s_waitcnt lgkmcnt(0)
    s_barrier
    s_add_u32 m0, s93, 98304
    s_nop 0
    buffer_load_dwordx4 v10, s[20:23], s78 offen lds
    s_add_u32 m0, s93, 102400
    s_nop 0
    buffer_load_dwordx4 v10, s[20:23], s79 offen lds
    s_add_u32 m0, s93, 106496
    s_nop 0
    buffer_load_dwordx4 v10, s[20:23], s80 offen lds
    s_add_u32 m0, s93, 110592
    s_nop 0
    buffer_load_dwordx4 v10, s[20:23], s81 offen lds
    v_mfma_f32_32x32x16_bf16 v[32:47], v[96:99], v[208:211], v[32:47]
    ds_read_b128 v[224:227], v12 offset:0
    ds_read_b64_tr_b16 v[80:81], v11 offset:24576
    ds_read_b64_tr_b16 v[82:83], v11 offset:24832
    v_mfma_f32_32x32x16_bf16 v[32:47], v[100:103], v[212:215], v[32:47]
    ds_read_b128 v[228:231], v13 offset:0
    ds_read_b64_tr_b16 v[84:85], v11 offset:25600
    ds_read_b64_tr_b16 v[86:87], v11 offset:25856
    v_mfma_f32_32x32x16_bf16 v[32:47], v[104:107], v[216:219], v[32:47]
    ds_read_b128 v[232:235], v14 offset:0
    ds_read_b64_tr_b16 v[88:89], v11 offset:26624
    ds_read_b64_tr_b16 v[90:91], v11 offset:26880
    v_mfma_f32_32x32x16_bf16 v[32:47], v[108:111], v[220:223], v[32:47]
    ds_read_b128 v[236:239], v15 offset:0
    ds_read_b64_tr_b16 v[92:93], v11 offset:27648
    ds_read_b64_tr_b16 v[94:95], v11 offset:27904
    ds_read_b128 v[60:63], v115 offset:49152
    ds_read_b128 v[64:67], v116 offset:50176
    ds_read_b128 v[68:71], v113 offset:640
    v_dot2c_f32_bf16 v118, v48, v56
    v_dot2c_f32_bf16 v119, v52, v56
    v_dot2c_f32_bf16 v118, v49, v57
    v_dot2c_f32_bf16 v119, v53, v57
    v_dot2c_f32_bf16 v118, v50, v58
    v_dot2c_f32_bf16 v119, v54, v58
    v_dot2c_f32_bf16 v118, v51, v59
    v_dot2c_f32_bf16 v119, v55, v59
    s_waitcnt vmcnt(4)
    s_waitcnt lgkmcnt(0)
    s_barrier
    s_add_u32 m0, s93, 114688
    s_nop 0
    buffer_load_dwordx4 v10, s[20:23], s82 offen lds
    s_add_u32 m0, s93, 118784
    s_nop 0
    buffer_load_dwordx4 v10, s[20:23], s83 offen lds
    s_add_u32 m0, s93, 122880
    s_nop 0
    buffer_load_dwordx4 v10, s[20:23], s84 offen lds
    s_add_u32 m0, s93, 126976
    s_nop 0
    buffer_load_dwordx4 v10, s[20:23], s85 offen lds
    v_mfma_f32_32x32x16_bf16 v[32:47], v[80:83], v[224:227], v[32:47]
    ds_read_b128 v[240:243], v12 offset:16384
    ds_read_b64_tr_b16 v[96:97], v11 offset:28672
    ds_read_b64_tr_b16 v[98:99], v11 offset:28928
    v_mfma_f32_32x32x16_bf16 v[32:47], v[84:87], v[228:231], v[32:47]
    ds_read_b128 v[244:247], v13 offset:16384
    ds_read_b64_tr_b16 v[100:101], v11 offset:29696
    ds_read_b64_tr_b16 v[102:103], v11 offset:29952
    v_mfma_f32_32x32x16_bf16 v[32:47], v[88:91], v[232:235], v[32:47]
    ds_read_b128 v[248:251], v14 offset:16384
    ds_read_b64_tr_b16 v[104:105], v11 offset:30720
    ds_read_b64_tr_b16 v[106:107], v11 offset:30976
    v_mfma_f32_32x32x16_bf16 v[32:47], v[92:95], v[236:239], v[32:47]
    ds_read_b128 v[252:255], v15 offset:16384
    ds_read_b64_tr_b16 v[108:109], v11 offset:31744
    ds_read_b64_tr_b16 v[110:111], v11 offset:32000
    ds_read_b128 v[48:51], v115 offset:0
    ds_read_b128 v[52:55], v116 offset:1024
    ds_read_b128 v[56:59], v113 offset:768
    v_dot2c_f32_bf16 v118, v60, v68
    v_dot2c_f32_bf16 v119, v64, v68
    v_dot2c_f32_bf16 v118, v61, v69
    v_dot2c_f32_bf16 v119, v65, v69
    v_dot2c_f32_bf16 v118, v62, v70
    v_dot2c_f32_bf16 v119, v66, v70
    v_dot2c_f32_bf16 v118, v63, v71
    v_dot2c_f32_bf16 v119, v67, v71
    s_waitcnt lgkmcnt(0)
    v_mfma_f32_32x32x16_bf16 v[32:47], v[96:99], v[240:243], v[32:47]
    v_mfma_f32_32x32x16_bf16 v[32:47], v[100:103], v[244:247], v[32:47]
    v_mfma_f32_32x32x16_bf16 v[32:47], v[104:107], v[248:251], v[32:47]
    v_mfma_f32_32x32x16_bf16 v[32:47], v[108:111], v[252:255], v[32:47]
    ds_read_b128 v[60:63], v115 offset:16384
    ds_read_b128 v[64:67], v116 offset:17408
    ds_read_b128 v[68:71], v113 offset:896
    v_dot2c_f32_bf16 v118, v48, v56
    v_dot2c_f32_bf16 v119, v52, v56
    v_dot2c_f32_bf16 v118, v49, v57
    v_dot2c_f32_bf16 v119, v53, v57
    v_dot2c_f32_bf16 v118, v50, v58
    v_dot2c_f32_bf16 v119, v54, v58
    v_dot2c_f32_bf16 v118, v51, v59
    v_dot2c_f32_bf16 v119, v55, v59
    v_add_u32 v11, 65536, v11
    v_cvt_pk_bf16_f32 v72, v32, v33
    v_cvt_pk_bf16_f32 v73, v34, v35
    v_cvt_pk_bf16_f32 v74, v36, v37
    v_cvt_pk_bf16_f32 v75, v38, v39
    s_nop 1
    v_mfma_f32_32x32x16_bf16 v[80:95], v[16:19], v[72:75], 0
    v_cvt_pk_bf16_f32 v76, v40, v41
    v_cvt_pk_bf16_f32 v77, v42, v43
    v_cvt_pk_bf16_f32 v78, v44, v45
    v_cvt_pk_bf16_f32 v79, v46, v47
    s_nop 1
    v_mfma_f32_32x32x16_bf16 v[96:111], v[20:23], v[76:79], 0
    s_waitcnt lgkmcnt(0)
    v_dot2c_f32_bf16 v118, v60, v68
    v_dot2c_f32_bf16 v119, v64, v68
    v_dot2c_f32_bf16 v118, v61, v69
    v_dot2c_f32_bf16 v119, v65, v69
    v_dot2c_f32_bf16 v118, v62, v70
    v_dot2c_f32_bf16 v119, v66, v70
    v_dot2c_f32_bf16 v118, v63, v71
    v_dot2c_f32_bf16 v119, v67, v71
    v_lshrrev_b32 v113, 3, v0
    s_lshl_b32 s94, s90, 6
    s_add_u32 s94, s94, 131584
    v_lshl_add_u32 v113, v113, 2, s94
    v_add_f32_dpp v118, v118, v118 quad_perm:[1,0,3,2] row_mask:0xf bank_mask:0xf
    v_add_f32_dpp v119, v119, v119 quad_perm:[1,0,3,2] row_mask:0xf bank_mask:0xf
    s_nop 0
    v_add_f32_dpp v118, v118, v118 quad_perm:[2,3,0,1] row_mask:0xf bank_mask:0xf
    v_add_f32_dpp v119, v119, v119 quad_perm:[2,3,0,1] row_mask:0xf bank_mask:0xf
    s_nop 0
    v_add_f32_dpp v118, v118, v118 row_half_mirror row_mask:0xf bank_mask:0xf
    v_add_f32_dpp v119, v119, v119 row_half_mirror row_mask:0xf bank_mask:0xf
    v_mul_f32 v118, s97, v118
    v_mul_f32 v119, s97, v119
    v_exp_f32 v118, v118
    v_exp_f32 v119, v119
    v_add_f32 v118, 1.0, v118
    v_add_f32 v119, 1.0, v119
    v_rcp_f32 v118, v118
    v_rcp_f32 v119, v119
    ds_write_b32 v113, v118
    ds_write_b32 v113, v119 offset:32
    s_mov_b32 s98, 0xffff
    s_mov_b32 s99, 0xffff
    s_mov_b32 s76, 0xffff0000
    s_mov_b32 s77, 0xffff0000
    s_add_u32 s94, s93, 139264
    v_add_u32 v12, s94, v3
    s_lshl_b32 s94, s90, 12
    s_add_u32 s94, s94, 139264
    v_add_u32 v13, s94, v3
    s_lshl_b32 s94, s90, 6
    s_add_u32 s94, s94, 155648
    v_and_b32 v15, 60, v0
    v_add_u32 v14, s94, v15
    v_lshlrev_b32 v15, 8, v15
    v_and_or_b32 v15, v3, 48, v15
    s_lshl_b32 s94, s89, 2
    s_add_u32 s94, s94, s90
    s_lshl_b32 s70, s94, 14
    s_add_u32 s70, s70, 524288
    s_lshl_b32 s71, s94, 10
    s_add_u32 s71, s71, 262144
    s_lshl_b32 s94, s88, 6
    s_add_u32 s72, s70, s94
    s_add_u32 s73, s71, s94
    s_lshl_b32 s94, s88, 10
    s_add_u32 s70, s70, s94
    s_lshl_b32 s94, s89, 2
    s_add_u32 s94, s94, s90
    s_lshl_b32 s94, s94, 7
    s_add_u32 s12, s94, 12288
    s_lshl_b32 s94, s88, 2
    s_add_u32 s13, s12, s94
    s_mov_b32 s55, 0x3f803f80
    s_lshl_b32 s94, s90, 8
    s_add_u32 s94, s94, 155648
    v_lshl_add_u32 v5, v0, 2, s94
    v_max3_f32 v72, v80, v81, v82
    v_max3_f32 v72, v72, v83, v84
    v_max3_f32 v72, v72, v85, v86
    v_max3_f32 v72, v72, v87, v88
    v_max3_f32 v72, v72, v89, v90
    v_max3_f32 v72, v72, v91, v92
    v_max3_f32 v72, v72, v93, v94
    v_max_f32 v72, v72, v95
    v_mul_f32 v72, s97, v72
    v_fma_f32 v80, v80, s96, v72
    v_fma_f32 v81, v81, s96, v72
    v_exp_f32 v80, v80
    v_fma_f32 v82, v82, s96, v72
    v_exp_f32 v81, v81
    v_fma_f32 v83, v83, s96, v72
    v_exp_f32 v82, v82
    v_fma_f32 v84, v84, s96, v72
    v_add_f32 v73, v80, v81
    v_exp_f32 v83, v83
    v_fma_f32 v85, v85, s96, v72
    v_add_f32 v73, v73, v82
    v_exp_f32 v84, v84
    v_fma_f32 v86, v86, s96, v72
    v_add_f32 v73, v73, v83
    v_exp_f32 v85, v85
    v_fma_f32 v87, v87, s96, v72
    v_add_f32 v73, v73, v84
    v_exp_f32 v86, v86
    v_fma_f32 v88, v88, s96, v72
    v_add_f32 v73, v73, v85
    s_waitcnt vmcnt(0)
    s_barrier
    s_setprio 2
    ds_read_b64_tr_b16 v[48:49], v11 offset:32768
    ds_read_b64_tr_b16 v[50:51], v11 offset:33024
    ds_read_b64_tr_b16 v[52:53], v11 offset:33792
    ds_read_b64_tr_b16 v[54:55], v11 offset:34048
    ds_read_b64_tr_b16 v[56:57], v11 offset:34816
    ds_read_b64_tr_b16 v[58:59], v11 offset:35072
    ds_read_b64_tr_b16 v[60:61], v11 offset:35840
    ds_read_b64_tr_b16 v[62:63], v11 offset:36096
    ds_read_b64_tr_b16 v[64:65], v11 offset:36864
    ds_read_b64_tr_b16 v[66:67], v11 offset:37120
    ds_read_b64_tr_b16 v[68:69], v11 offset:37888
    ds_read_b64_tr_b16 v[70:71], v11 offset:38144
    v_exp_f32 v87, v87
    v_fma_f32 v89, v89, s96, v72
    v_add_f32 v73, v73, v86
    v_exp_f32 v88, v88
    v_fma_f32 v90, v90, s96, v72
    s_waitcnt lgkmcnt(10)
    v_mfma_f32_32x32x16_bf16 v[32:47], v[128:131], v[48:51], 0
    s_add_u32 m0, s93, 65536
    s_nop 0
    buffer_load_dwordx4 v10, s[24:27], s78 offen lds
    v_add_f32 v73, v73, v87
    v_exp_f32 v89, v89
    v_fma_f32 v91, v91, s96, v72
    v_add_f32 v73, v73, v88
    v_exp_f32 v90, v90
    v_fma_f32 v92, v92, s96, v72
    ds_read_b64_tr_b16 v[48:49], v11 offset:38912
    ds_read_b64_tr_b16 v[50:51], v11 offset:39168
    s_waitcnt lgkmcnt(10)
    v_mfma_f32_32x32x16_bf16 v[32:47], v[132:135], v[52:55], v[32:47]
    v_add_f32 v73, v73, v89
    v_exp_f32 v91, v91
    v_fma_f32 v93, v93, s96, v72
    v_add_f32 v73, v73, v90
    v_exp_f32 v92, v92
    v_fma_f32 v94, v94, s96, v72
    ds_read_b64_tr_b16 v[52:53], v11 offset:39936
    ds_read_b64_tr_b16 v[54:55], v11 offset:40192
    s_waitcnt lgkmcnt(10)
    v_mfma_f32_32x32x16_bf16 v[32:47], v[136:139], v[56:59], v[32:47]
    s_add_u32 m0, s93, 69632
    s_nop 0
    buffer_load_dwordx4 v10, s[24:27], s79 offen lds
    v_add_f32 v73, v73, v91
    v_exp_f32 v93, v93
    v_fma_f32 v95, v95, s96, v72
    v_add_f32 v73, v73, v92
    v_exp_f32 v94, v94
    v_add_f32 v73, v73, v93
    ds_read_b64_tr_b16 v[56:57], v11 offset:40960
    ds_read_b64_tr_b16 v[58:59], v11 offset:41216
    s_waitcnt lgkmcnt(10)
    v_mfma_f32_32x32x16_bf16 v[32:47], v[140:143], v[60:63], v[32:47]
    v_exp_f32 v95, v95
    v_add_f32 v73, v73, v94
    v_add_f32 v73, v73, v95
    v_rcp_f32 v73, v73
    s_nop 0
    v_mul_f32 v80, v80, v73
    v_mul_f32 v81, v81, v73
    ds_read_b64_tr_b16 v[60:61], v11 offset:41984
    ds_read_b64_tr_b16 v[62:63], v11 offset:42240
    s_waitcnt lgkmcnt(10)
    v_mfma_f32_32x32x16_bf16 v[32:47], v[144:147], v[64:67], v[32:47]
    s_add_u32 m0, s93, 73728
    s_nop 0
    buffer_load_dwordx4 v10, s[24:27], s80 offen lds
    v_cvt_pk_bf16_f32 v112, v80, v81
    v_mul_f32 v82, v82, v73
    v_mul_f32 v83, v83, v73
    v_cvt_pk_bf16_f32 v113, v82, v83
    v_mul_f32 v84, v84, v73
    ds_read_b64_tr_b16 v[64:65], v11 offset:43008
    ds_read_b64_tr_b16 v[66:67], v11 offset:43264
    s_waitcnt lgkmcnt(10)
    v_mfma_f32_32x32x16_bf16 v[32:47], v[148:151], v[68:71], v[32:47]
    v_mul_f32 v85, v85, v73
    v_cvt_pk_bf16_f32 v114, v84, v85
    v_mul_f32 v86, v86, v73
    v_mul_f32 v87, v87, v73
    v_cvt_pk_bf16_f32 v115, v86, v87
    v_mul_f32 v88, v88, v73
    ds_read_b64_tr_b16 v[68:69], v11 offset:44032
    ds_read_b64_tr_b16 v[70:71], v11 offset:44288
    s_waitcnt lgkmcnt(10)
    v_mfma_f32_32x32x16_bf16 v[32:47], v[152:155], v[48:51], v[32:47]
    s_add_u32 m0, s93, 77824
    s_nop 0
    buffer_load_dwordx4 v10, s[24:27], s81 offen lds
    v_mul_f32 v89, v89, v73
    v_cvt_pk_bf16_f32 v116, v88, v89
    v_mul_f32 v90, v90, v73
    v_mul_f32 v91, v91, v73
    v_cvt_pk_bf16_f32 v117, v90, v91
    v_mul_f32 v92, v92, v73
    ds_read_b64_tr_b16 v[48:49], v11 offset:45056
    ds_read_b64_tr_b16 v[50:51], v11 offset:45312
    s_waitcnt lgkmcnt(10)
    v_mfma_f32_32x32x16_bf16 v[32:47], v[156:159], v[52:55], v[32:47]
    v_mul_f32 v93, v93, v73
    v_cvt_pk_bf16_f32 v118, v92, v93
    v_mul_f32 v94, v94, v73
    v_mul_f32 v95, v95, v73
    v_cvt_pk_bf16_f32 v119, v94, v95
    v_mfma_f32_32x32x16_bf16 v[80:95], v[112:115], v[24:27], 0
    ds_read_b64_tr_b16 v[52:53], v11 offset:46080
    ds_read_b64_tr_b16 v[54:55], v11 offset:46336
    s_waitcnt lgkmcnt(10)
    v_mfma_f32_32x32x16_bf16 v[32:47], v[160:163], v[56:59], v[32:47]
    v_mfma_f32_32x32x16_bf16 v[80:95], v[116:119], v[28:31], v[80:95]
    v_max3_f32 v72, v96, v97, v98
    v_max3_f32 v72, v72, v99, v100
    v_max3_f32 v72, v72, v101, v102
    v_max3_f32 v72, v72, v103, v104
    v_max3_f32 v72, v72, v105, v106
    ds_read_b64_tr_b16 v[56:57], v11 offset:47104
    ds_read_b64_tr_b16 v[58:59], v11 offset:47360
    s_waitcnt lgkmcnt(10)
    v_mfma_f32_32x32x16_bf16 v[32:47], v[164:167], v[60:63], v[32:47]
    s_add_u32 m0, s93, 81920
    s_nop 0
    buffer_load_dwordx4 v10, s[24:27], s82 offen lds
    v_max3_f32 v72, v72, v107, v108
    v_max3_f32 v72, v72, v109, v110
    v_max_f32 v72, v72, v111
    v_mul_f32 v72, s97, v72
    v_fma_f32 v96, v96, s96, v72
    ds_read_b64_tr_b16 v[60:61], v11 offset:48128
    ds_read_b64_tr_b16 v[62:63], v11 offset:48384
    s_waitcnt lgkmcnt(10)
    v_mfma_f32_32x32x16_bf16 v[32:47], v[168:171], v[64:67], v[32:47]
    v_fma_f32 v97, v97, s96, v72
    v_exp_f32 v96, v96
    v_fma_f32 v98, v98, s96, v72
    v_exp_f32 v97, v97
    v_fma_f32 v99, v99, s96, v72
    v_exp_f32 v98, v98
    ds_read_b64_tr_b16 v[64:65], v11 offset:49152
    ds_read_b64_tr_b16 v[66:67], v11 offset:49408
    s_waitcnt lgkmcnt(10)
    v_mfma_f32_32x32x16_bf16 v[32:47], v[172:175], v[68:71], v[32:47]
    s_add_u32 m0, s93, 86016
    s_nop 0
    buffer_load_dwordx4 v10, s[24:27], s83 offen lds
    v_fma_f32 v100, v100, s96, v72
    v_add_f32 v73, v96, v97
    v_exp_f32 v99, v99
    v_fma_f32 v101, v101, s96, v72
    v_add_f32 v73, v73, v98
    v_exp_f32 v100, v100
    ds_read_b64_tr_b16 v[68:69], v11 offset:50176
    ds_read_b64_tr_b16 v[70:71], v11 offset:50432
    s_waitcnt lgkmcnt(10)
    v_mfma_f32_32x32x16_bf16 v[32:47], v[176:179], v[48:51], v[32:47]
    v_fma_f32 v102, v102, s96, v72
    v_add_f32 v73, v73, v99
    v_exp_f32 v101, v101
    v_fma_f32 v103, v103, s96, v72
    v_add_f32 v73, v73, v100
    v_exp_f32 v102, v102
    ds_read_b64_tr_b16 v[48:49], v11 offset:51200
    ds_read_b64_tr_b16 v[50:51], v11 offset:51456
    s_waitcnt lgkmcnt(10)
    v_mfma_f32_32x32x16_bf16 v[32:47], v[180:183], v[52:55], v[32:47]
    s_add_u32 m0, s93, 90112
    s_nop 0
    buffer_load_dwordx4 v10, s[24:27], s84 offen lds
    v_fma_f32 v104, v104, s96, v72
    v_add_f32 v73, v73, v101
    v_exp_f32 v103, v103
    v_fma_f32 v105, v105, s96, v72
    v_add_f32 v73, v73, v102
    v_exp_f32 v104, v104
    ds_read_b64_tr_b16 v[52:53], v11 offset:52224
    ds_read_b64_tr_b16 v[54:55], v11 offset:52480
    s_waitcnt lgkmcnt(10)
    v_mfma_f32_32x32x16_bf16 v[32:47], v[184:187], v[56:59], v[32:47]
    v_fma_f32 v106, v106, s96, v72
    v_add_f32 v73, v73, v103
    v_exp_f32 v105, v105
    v_fma_f32 v107, v107, s96, v72
    v_add_f32 v73, v73, v104
    v_exp_f32 v106, v106
    ds_read_b64_tr_b16 v[56:57], v11 offset:53248
    ds_read_b64_tr_b16 v[58:59], v11 offset:53504
    s_waitcnt lgkmcnt(10)
    v_mfma_f32_32x32x16_bf16 v[32:47], v[188:191], v[60:63], v[32:47]
    s_add_u32 m0, s93, 94208
    s_nop 0
    buffer_load_dwordx4 v10, s[24:27], s85 offen lds
    v_fma_f32 v108, v108, s96, v72
    v_add_f32 v73, v73, v105
    v_exp_f32 v107, v107
    v_fma_f32 v109, v109, s96, v72
    v_add_f32 v73, v73, v106
    ds_read_b64_tr_b16 v[60:61], v11 offset:54272
    ds_read_b64_tr_b16 v[62:63], v11 offset:54528
    s_waitcnt lgkmcnt(10)
    v_mfma_f32_32x32x16_bf16 v[32:47], v[192:195], v[64:67], v[32:47]
    v_exp_f32 v108, v108
    v_fma_f32 v110, v110, s96, v72
    v_add_f32 v73, v73, v107
    v_exp_f32 v109, v109
    v_fma_f32 v111, v111, s96, v72
    v_add_f32 v73, v73, v108
    ds_read_b64_tr_b16 v[64:65], v11 offset:55296
    ds_read_b64_tr_b16 v[66:67], v11 offset:55552
    s_waitcnt lgkmcnt(10)
    v_mfma_f32_32x32x16_bf16 v[32:47], v[196:199], v[68:71], v[32:47]
    v_exp_f32 v110, v110
    v_add_f32 v73, v73, v109
    v_exp_f32 v111, v111
    v_add_f32 v73, v73, v110
    v_add_f32 v73, v73, v111
    v_rcp_f32 v73, v73
    ds_read_b64_tr_b16 v[68:69], v11 offset:56320
    ds_read_b64_tr_b16 v[70:71], v11 offset:56576
    s_waitcnt lgkmcnt(10)
    v_mfma_f32_32x32x16_bf16 v[32:47], v[200:203], v[48:51], v[32:47]
    v_mul_f32 v96, v96, v73
    v_mul_f32 v97, v97, v73
    v_cvt_pk_bf16_f32 v120, v96, v97
    v_mul_f32 v98, v98, v73
    v_mul_f32 v99, v99, v73
    v_cvt_pk_bf16_f32 v121, v98, v99
    ds_read_b64_tr_b16 v[48:49], v11 offset:57344
    ds_read_b64_tr_b16 v[50:51], v11 offset:57600
    s_waitcnt lgkmcnt(10)
    v_mfma_f32_32x32x16_bf16 v[32:47], v[204:207], v[52:55], v[32:47]
    v_mul_f32 v100, v100, v73
    v_mul_f32 v101, v101, v73
    v_cvt_pk_bf16_f32 v122, v100, v101
    v_mul_f32 v102, v102, v73
    v_mul_f32 v103, v103, v73
    v_cvt_pk_bf16_f32 v123, v102, v103
    ds_read_b64_tr_b16 v[52:53], v11 offset:58368
    ds_read_b64_tr_b16 v[54:55], v11 offset:58624
    s_waitcnt lgkmcnt(10)
    v_mfma_f32_32x32x16_bf16 v[32:47], v[208:211], v[56:59], v[32:47]
    v_mul_f32 v104, v104, v73
    v_mul_f32 v105, v105, v73
    v_cvt_pk_bf16_f32 v124, v104, v105
    v_mul_f32 v106, v106, v73
    v_mul_f32 v107, v107, v73
    ds_read_b64_tr_b16 v[56:57], v11 offset:59392
    ds_read_b64_tr_b16 v[58:59], v11 offset:59648
    s_waitcnt lgkmcnt(10)
    v_mfma_f32_32x32x16_bf16 v[32:47], v[212:215], v[60:63], v[32:47]
    v_cvt_pk_bf16_f32 v125, v106, v107
    v_mul_f32 v108, v108, v73
    v_mul_f32 v109, v109, v73
    v_cvt_pk_bf16_f32 v126, v108, v109
    v_mul_f32 v110, v110, v73
    v_mul_f32 v111, v111, v73
    ds_read_b64_tr_b16 v[60:61], v11 offset:60416
    ds_read_b64_tr_b16 v[62:63], v11 offset:60672
    s_waitcnt lgkmcnt(10)
    v_mfma_f32_32x32x16_bf16 v[32:47], v[216:219], v[64:67], v[32:47]
    v_cvt_pk_bf16_f32 v127, v110, v111
    v_mfma_f32_32x32x16_bf16 v[96:111], v[120:123], v[24:27], 0
    s_nop 0
    v_mfma_f32_32x32x16_bf16 v[96:111], v[124:127], v[28:31], v[96:111]
    v_mov_b32 v76, 0
    v_mov_b32 v77, 0
    v_cvt_pk_bf16_f32 v112, v80, v81
    ds_read_b64_tr_b16 v[64:65], v11 offset:61440
    ds_read_b64_tr_b16 v[66:67], v11 offset:61696
    s_waitcnt lgkmcnt(10)
    v_mfma_f32_32x32x16_bf16 v[32:47], v[220:223], v[68:71], v[32:47]
    v_cvt_pk_bf16_f32 v113, v82, v83
    v_cvt_pk_bf16_f32 v114, v84, v85
    v_cvt_pk_bf16_f32 v115, v86, v87
    v_cvt_pk_bf16_f32 v116, v88, v89
    v_cvt_pk_bf16_f32 v117, v90, v91
    v_cvt_pk_bf16_f32 v118, v92, v93
    ds_read_b64_tr_b16 v[68:69], v11 offset:62464
    ds_read_b64_tr_b16 v[70:71], v11 offset:62720
    s_waitcnt lgkmcnt(10)
    v_mfma_f32_32x32x16_bf16 v[32:47], v[224:227], v[48:51], v[32:47]
    v_cvt_pk_bf16_f32 v119, v94, v95
    v_mov_b32 v80, 0
    v_mov_b32 v81, 0
    v_mov_b32 v82, 0
    v_mov_b32 v83, 0
    v_mov_b32 v84, 0
    ds_read_b64_tr_b16 v[48:49], v11 offset:63488
    ds_read_b64_tr_b16 v[50:51], v11 offset:63744
    s_waitcnt lgkmcnt(10)
    v_mfma_f32_32x32x16_bf16 v[32:47], v[228:231], v[52:55], v[32:47]
    v_mov_b32 v85, 0
    v_mov_b32 v86, 0
    v_mov_b32 v87, 0
    v_mov_b32 v88, 0
    v_mov_b32 v89, 0
    ds_read_b64_tr_b16 v[52:53], v11 offset:64512
    ds_read_b64_tr_b16 v[54:55], v11 offset:64768
    s_waitcnt lgkmcnt(10)
    v_mfma_f32_32x32x16_bf16 v[32:47], v[232:235], v[56:59], v[32:47]
    v_mov_b32 v90, 0
    v_mov_b32 v91, 0
    v_mov_b32 v92, 0
    v_mov_b32 v93, 0
    v_mov_b32 v94, 0
    v_mov_b32 v95, 0
    s_waitcnt lgkmcnt(8)
    v_mfma_f32_32x32x16_bf16 v[32:47], v[236:239], v[60:63], v[32:47]
    v_cvt_pk_bf16_f32 v120, v96, v97
    v_cvt_pk_bf16_f32 v121, v98, v99
    v_cvt_pk_bf16_f32 v122, v100, v101
    v_cvt_pk_bf16_f32 v123, v102, v103
    v_cvt_pk_bf16_f32 v124, v104, v105
    v_cvt_pk_bf16_f32 v125, v106, v107
    s_waitcnt lgkmcnt(6)
    v_mfma_f32_32x32x16_bf16 v[32:47], v[240:243], v[64:67], v[32:47]
    v_cvt_pk_bf16_f32 v126, v108, v109
    v_cvt_pk_bf16_f32 v127, v110, v111
    v_dot2c_f32_bf16 v76, s55, v112
    v_dot2c_f32_bf16 v77, s55, v120
    v_dot2c_f32_bf16 v76, s55, v113
    v_dot2c_f32_bf16 v77, s55, v121
    s_waitcnt lgkmcnt(4)
    v_mfma_f32_32x32x16_bf16 v[32:47], v[244:247], v[68:71], v[32:47]
    v_dot2c_f32_bf16 v76, s55, v114
    v_dot2c_f32_bf16 v77, s55, v122
    v_dot2c_f32_bf16 v76, s55, v115
    v_dot2c_f32_bf16 v77, s55, v123
    v_dot2c_f32_bf16 v76, s55, v116
    v_dot2c_f32_bf16 v77, s55, v124
    s_waitcnt lgkmcnt(2)
    v_mfma_f32_32x32x16_bf16 v[32:47], v[248:251], v[48:51], v[32:47]
    v_dot2c_f32_bf16 v76, s55, v117
    v_dot2c_f32_bf16 v77, s55, v125
    v_dot2c_f32_bf16 v76, s55, v118
    v_dot2c_f32_bf16 v77, s55, v126
    v_dot2c_f32_bf16 v76, s55, v119
    v_dot2c_f32_bf16 v77, s55, v127
    s_waitcnt lgkmcnt(0)
    v_mfma_f32_32x32x16_bf16 v[32:47], v[252:255], v[52:55], v[32:47]
    s_nop 0
    v_permlane32_swap_b32 v76, v77
    v_add_f32 v76, v76, v77
    ds_write_b32 v5, v76
    s_mov_b64 exec, s[98:99]
    s_nop 6
    v_cvt_pk_bf16_f32 v80, v32, v33
    v_cvt_pk_bf16_f32 v81, v34, v35
    v_cvt_pk_bf16_f32 v82, v36, v37
    v_cvt_pk_bf16_f32 v83, v38, v39
    s_mov_b64 exec, s[76:77]
    v_cvt_pk_bf16_f32 v88, v32, v33
    v_cvt_pk_bf16_f32 v89, v34, v35
    v_cvt_pk_bf16_f32 v90, v36, v37
    v_cvt_pk_bf16_f32 v91, v38, v39
    s_mov_b64 exec, -1
    v_mfma_f32_32x32x16_bf16 v[96:111], v[112:115], v[80:83], 0
    v_mfma_f32_32x32x16_bf16 v[96:111], v[120:123], v[88:91], v[96:111]
    s_mov_b64 exec, s[98:99]
    v_cvt_pk_bf16_f32 v84, v40, v41
    v_cvt_pk_bf16_f32 v85, v42, v43
    v_cvt_pk_bf16_f32 v86, v44, v45
    v_cvt_pk_bf16_f32 v87, v46, v47
    s_mov_b64 exec, s[76:77]
    v_cvt_pk_bf16_f32 v92, v40, v41
    v_cvt_pk_bf16_f32 v93, v42, v43
    v_cvt_pk_bf16_f32 v94, v44, v45
    v_cvt_pk_bf16_f32 v95, v46, v47
    s_mov_b64 exec, -1
    v_mfma_f32_32x32x16_bf16 v[96:111], v[116:119], v[84:87], v[96:111]
    v_mfma_f32_32x32x16_bf16 v[96:111], v[124:127], v[92:95], v[96:111]
    s_and_b32 s95, s89, 7
    s_lshl_b32 s94, s90, 16
    s_lshl_b32 s95, s95, 7
    s_add_u32 s94, s94, s95
    s_add_u32 s8, s60, s94
    s_addc_u32 s9, s61, 0
    s_sub_u32 s10, 524288, s94
    s_mov_b32 s11, 0x20000
    s_lshl_b32 s94, s88, 2
    s_add_u32 s94, s94, s90
    s_lshl_b32 s94, s94, 4
    s_add_u32 s94, s94, s89
    s_mul_i32 s94, s94, 2048
    s_add_u32 s75, s94, 7340032
    s_waitcnt vmcnt(0)
    ds_write_b128 v12, v[96:99] offset:0
    ds_write_b128 v12, v[100:103] offset:4096
    ds_write_b128 v12, v[104:107] offset:8192
    ds_write_b128 v12, v[108:111] offset:12288
    v_mov_b32 v48, 3
    s_mov_b64 exec, 1
    ds_write_b32 v1, v48
    s_mov_b64 exec, -1
    v_mov_b32 v72, s86
    s_mov_b64 exec, 1
    buffer_store_dword v72, off, s[28:31], s13 sc1
    s_mov_b64 exec, -1
    v_lshrrev_b32 v6, 3, v0
    v_lshlrev_b32 v6, 10, v6
    v_and_b32 v7, 7, v0
    v_bfe_u32 v8, v0, 4, 1
    v_lshlrev_b32 v8, 2, v8
    v_xor_b32 v7, v7, v8
    v_lshl_add_u32 v6, v7, 4, v6
    v_add_u32 v7, 7168, v6
    v_add_u32 v8, 14336, v6
    v_add_u32 v9, 21504, v6
    s_lshl_b32 s74, s90, 13
    v_lshlrev_b32 v5, 2, v0
L_rs1:
    ds_read_b128 v[48:51], v2
    s_waitcnt lgkmcnt(0)
    v_min3_u32 v48, v48, v49, v50
    v_min_u32 v48, v48, v51
    v_cmp_gt_u32 vcc, 3, v48
    s_cbranch_vccnz L_rs1
    ds_read_b32 v72, v14 offset:0
    ds_read_b32 v73, v14 offset:256
    ds_read_b32 v74, v14 offset:512
    ds_read_b32 v75, v14 offset:768
    ds_read_b128 v[96:99], v13 offset:0
    ds_read_b128 v[100:103], v13 offset:1024
    ds_read_b128 v[104:107], v13 offset:2048
    ds_read_b128 v[108:111], v13 offset:3072
    v_mov_b32 v79, s86
    s_waitcnt lgkmcnt(4)
    v_pk_add_f32 v[72:73], v[72:73], v[74:75]
    s_waitcnt lgkmcnt(2)
    v_pk_add_f32 v[96:97], v[96:97], v[100:101]
    v_pk_add_f32 v[98:99], v[98:99], v[102:103]
    v_add_f32 v78, v72, v73
    s_waitcnt lgkmcnt(0)
    v_pk_add_f32 v[104:105], v[104:105], v[108:109]
    v_pk_add_f32 v[106:107], v[106:107], v[110:111]
    v_pk_add_f32 v[96:97], v[96:97], v[104:105]
    v_pk_add_f32 v[98:99], v[98:99], v[106:107]
    v_cvt_pk_bf16_f32 v76, v96, v97
    v_cvt_pk_bf16_f32 v77, v98, v99
    buffer_store_dwordx4 v[76:79], v15, s[28:31], s72 offen sc1
    s_setprio 0
    ds_read_b64_tr_b16 v[48:49], v11 offset:0
    ds_read_b64_tr_b16 v[50:51], v11 offset:256
    ds_read_b64_tr_b16 v[52:53], v11 offset:1024
    ds_read_b64_tr_b16 v[54:55], v11 offset:1280
    ds_read_b64_tr_b16 v[56:57], v11 offset:2048
    ds_read_b64_tr_b16 v[58:59], v11 offset:2304
    ds_read_b64_tr_b16 v[60:61], v11 offset:3072
    ds_read_b64_tr_b16 v[62:63], v11 offset:3328
    ds_read_b64_tr_b16 v[64:65], v11 offset:4096
    ds_read_b64_tr_b16 v[66:67], v11 offset:4352
    ds_read_b64_tr_b16 v[68:69], v11 offset:5120
    ds_read_b64_tr_b16 v[70:71], v11 offset:5376
    s_waitcnt lgkmcnt(10)
    v_mfma_f32_32x32x16_bf16 v[32:47], v[48:51], v[128:131], 0
    v_mov_b32 v12, 0
    s_mov_b64 exec, 0xffff
    buffer_atomic_add v12, v5, s[28:31], s12 offen sc0 sc1
    s_mov_b64 exec, -1
    ds_read_b64_tr_b16 v[48:49], v11 offset:6144
    ds_read_b64_tr_b16 v[50:51], v11 offset:6400
    s_waitcnt lgkmcnt(10)
    v_mfma_f32_32x32x16_bf16 v[32:47], v[52:55], v[132:135], v[32:47]
    ds_read_b64_tr_b16 v[52:53], v11 offset:7168
    ds_read_b64_tr_b16 v[54:55], v11 offset:7424
    s_waitcnt lgkmcnt(10)
    v_mfma_f32_32x32x16_bf16 v[32:47], v[56:59], v[136:139], v[32:47]
    ds_read_b64_tr_b16 v[56:57], v11 offset:8192
    ds_read_b64_tr_b16 v[58:59], v11 offset:8448
    s_waitcnt lgkmcnt(10)
    v_mfma_f32_32x32x16_bf16 v[32:47], v[60:63], v[140:143], v[32:47]
    ds_read_b64_tr_b16 v[60:61], v11 offset:9216
    ds_read_b64_tr_b16 v[62:63], v11 offset:9472
    s_waitcnt lgkmcnt(10)
    v_mfma_f32_32x32x16_bf16 v[32:47], v[64:67], v[144:147], v[32:47]
    ds_read_b64_tr_b16 v[64:65], v11 offset:10240
    ds_read_b64_tr_b16 v[66:67], v11 offset:10496
    s_waitcnt lgkmcnt(10)
    v_mfma_f32_32x32x16_bf16 v[32:47], v[68:71], v[148:151], v[32:47]
    ds_read_b64_tr_b16 v[68:69], v11 offset:11264
    ds_read_b64_tr_b16 v[70:71], v11 offset:11520
    s_waitcnt lgkmcnt(10)
    v_mfma_f32_32x32x16_bf16 v[32:47], v[48:51], v[152:155], v[32:47]
    ds_read_b64_tr_b16 v[48:49], v11 offset:12288
    ds_read_b64_tr_b16 v[50:51], v11 offset:12544
    s_waitcnt lgkmcnt(10)
    v_mfma_f32_32x32x16_bf16 v[32:47], v[52:55], v[156:159], v[32:47]
    ds_read_b64_tr_b16 v[52:53], v11 offset:13312
    ds_read_b64_tr_b16 v[54:55], v11 offset:13568
    s_waitcnt lgkmcnt(10)
    v_mfma_f32_32x32x16_bf16 v[32:47], v[56:59], v[160:163], v[32:47]
    ds_read_b64_tr_b16 v[56:57], v11 offset:14336
    ds_read_b64_tr_b16 v[58:59], v11 offset:14592
    s_waitcnt lgkmcnt(10)
    v_mfma_f32_32x32x16_bf16 v[32:47], v[60:63], v[164:167], v[32:47]
    ds_read_b64_tr_b16 v[60:61], v11 offset:15360
    ds_read_b64_tr_b16 v[62:63], v11 offset:15616
    s_waitcnt lgkmcnt(10)
    v_mfma_f32_32x32x16_bf16 v[32:47], v[64:67], v[168:171], v[32:47]
    ds_read_b64_tr_b16 v[64:65], v11 offset:16384
    ds_read_b64_tr_b16 v[66:67], v11 offset:16640
    s_waitcnt lgkmcnt(10)
    v_mfma_f32_32x32x16_bf16 v[32:47], v[68:71], v[172:175], v[32:47]
    ds_read_b64_tr_b16 v[68:69], v11 offset:17408
    ds_read_b64_tr_b16 v[70:71], v11 offset:17664
    s_waitcnt lgkmcnt(10)
    v_mfma_f32_32x32x16_bf16 v[32:47], v[48:51], v[176:179], v[32:47]
    ds_read_b64_tr_b16 v[48:49], v11 offset:18432
    ds_read_b64_tr_b16 v[50:51], v11 offset:18688
    s_waitcnt lgkmcnt(10)
    v_mfma_f32_32x32x16_bf16 v[32:47], v[52:55], v[180:183], v[32:47]
    ds_read_b64_tr_b16 v[52:53], v11 offset:19456
    ds_read_b64_tr_b16 v[54:55], v11 offset:19712
    s_waitcnt lgkmcnt(10)
    v_mfma_f32_32x32x16_bf16 v[32:47], v[56:59], v[184:187], v[32:47]
    ds_read_b64_tr_b16 v[56:57], v11 offset:20480
    ds_read_b64_tr_b16 v[58:59], v11 offset:20736
    s_waitcnt lgkmcnt(10)
    v_mfma_f32_32x32x16_bf16 v[32:47], v[60:63], v[188:191], v[32:47]
    ds_read_b64_tr_b16 v[60:61], v11 offset:21504
    ds_read_b64_tr_b16 v[62:63], v11 offset:21760
    s_waitcnt lgkmcnt(10)
    v_mfma_f32_32x32x16_bf16 v[32:47], v[64:67], v[192:195], v[32:47]
    ds_read_b64_tr_b16 v[64:65], v11 offset:22528
    ds_read_b64_tr_b16 v[66:67], v11 offset:22784
    s_waitcnt lgkmcnt(10)
    v_mfma_f32_32x32x16_bf16 v[32:47], v[68:71], v[196:199], v[32:47]
    ds_read_b64_tr_b16 v[68:69], v11 offset:23552
    ds_read_b64_tr_b16 v[70:71], v11 offset:23808
    s_waitcnt lgkmcnt(10)
    v_mfma_f32_32x32x16_bf16 v[32:47], v[48:51], v[200:203], v[32:47]
    ds_read_b64_tr_b16 v[48:49], v11 offset:24576
    ds_read_b64_tr_b16 v[50:51], v11 offset:24832
    s_waitcnt lgkmcnt(10)
    v_mfma_f32_32x32x16_bf16 v[32:47], v[52:55], v[204:207], v[32:47]
    ds_read_b64_tr_b16 v[52:53], v11 offset:25600
    ds_read_b64_tr_b16 v[54:55], v11 offset:25856
    s_waitcnt lgkmcnt(10)
    v_mfma_f32_32x32x16_bf16 v[32:47], v[56:59], v[208:211], v[32:47]
    ds_read_b64_tr_b16 v[56:57], v11 offset:26624
    ds_read_b64_tr_b16 v[58:59], v11 offset:26880
    s_waitcnt lgkmcnt(10)
    v_mfma_f32_32x32x16_bf16 v[32:47], v[60:63], v[212:215], v[32:47]
    ds_read_b64_tr_b16 v[60:61], v11 offset:27648
    ds_read_b64_tr_b16 v[62:63], v11 offset:27904
    s_waitcnt lgkmcnt(10)
    v_mfma_f32_32x32x16_bf16 v[32:47], v[64:67], v[216:219], v[32:47]
    s_waitcnt vmcnt(0)
    v_cmp_ne_u32 vcc, s86, v12
    s_nop 0
    s_and_b64 vcc, vcc, 0xffff
    s_cbranch_scc0 L_pd3
    s_mov_b32 s94, 20000
L_pl2:
    s_sleep 2
    v_mov_b32 v12, 0
    s_mov_b64 exec, 0xffff
    buffer_atomic_add v12, v5, s[28:31], s12 offen sc0 sc1
    s_mov_b64 exec, -1
    s_sub_u32 s94, s94, 1
    s_waitcnt vmcnt(0)
    s_cbranch_scc1 L_pd3
    v_cmp_ne_u32 vcc, s86, v12
    s_nop 0
    s_and_b64 vcc, vcc, 0xffff
    s_cbranch_scc1 L_pl2
    s_sleep 4
L_pd3:
    s_mov_b64 exec, 0xffff
    buffer_load_dwordx4 v[128:131], v3, s[28:31], s70 offen offset:0 sc1
    buffer_load_dwordx4 v[132:135], v3, s[28:31], s70 offen offset:256 sc1
    buffer_load_dwordx4 v[136:139], v3, s[28:31], s70 offen offset:512 sc1
    buffer_load_dwordx4 v[140:143], v3, s[28:31], s70 offen offset:768 sc1
    s_mov_b64 exec, -1
    s_add_u32 s12, s12, 64
    s_add_u32 s13, s13, 64
    v_mov_b32 v13, s86
    s_mov_b64 exec, 1
    buffer_store_dword v13, off, s[28:31], s13 sc1
    s_mov_b64 exec, -1
    ds_read_b64_tr_b16 v[64:65], v11 offset:28672
    ds_read_b64_tr_b16 v[66:67], v11 offset:28928
    s_waitcnt lgkmcnt(10)
    v_mfma_f32_32x32x16_bf16 v[32:47], v[68:71], v[220:223], v[32:47]
    ds_read_b64_tr_b16 v[68:69], v11 offset:29696
    ds_read_b64_tr_b16 v[70:71], v11 offset:29952
    s_waitcnt lgkmcnt(10)
    v_mfma_f32_32x32x16_bf16 v[32:47], v[48:51], v[224:227], v[32:47]
    ds_read_b64_tr_b16 v[48:49], v11 offset:30720
    ds_read_b64_tr_b16 v[50:51], v11 offset:30976
    s_waitcnt lgkmcnt(10)
    v_mfma_f32_32x32x16_bf16 v[32:47], v[52:55], v[228:231], v[32:47]
    ds_read_b64_tr_b16 v[52:53], v11 offset:31744
    ds_read_b64_tr_b16 v[54:55], v11 offset:32000
    s_waitcnt lgkmcnt(10)
    v_mfma_f32_32x32x16_bf16 v[32:47], v[56:59], v[232:235], v[32:47]
    s_waitcnt lgkmcnt(8)
    v_mfma_f32_32x32x16_bf16 v[32:47], v[60:63], v[236:239], v[32:47]
    s_waitcnt lgkmcnt(6)
    v_mfma_f32_32x32x16_bf16 v[32:47], v[64:67], v[240:243], v[32:47]
    s_waitcnt lgkmcnt(4)
    v_mfma_f32_32x32x16_bf16 v[32:47], v[68:71], v[244:247], v[32:47]
    s_waitcnt lgkmcnt(2)
    v_mfma_f32_32x32x16_bf16 v[32:47], v[48:51], v[248:251], v[32:47]
    s_waitcnt lgkmcnt(0)
    v_mfma_f32_32x32x16_bf16 v[32:47], v[52:55], v[252:255], v[32:47]
    v_mov_b32 v48, 4
    s_mov_b64 exec, 1
    ds_write_b32 v1, v48
    s_mov_b64 exec, -1
    s_setprio 2
    s_nop 6
    v_cvt_pk_bf16_f32 v72, v32, v33
    v_cvt_pk_bf16_f32 v73, v34, v35
    v_cvt_pk_bf16_f32 v74, v36, v37
    v_cvt_pk_bf16_f32 v75, v38, v39
    s_nop 1
    v_mfma_f32_32x32x16_bf16 v[80:95], v[16:19], v[72:75], 0
    v_cvt_pk_bf16_f32 v76, v40, v41
    v_cvt_pk_bf16_f32 v77, v42, v43
    v_cvt_pk_bf16_f32 v78, v44, v45
    v_cvt_pk_bf16_f32 v79, v46, v47
    s_nop 1
    v_mfma_f32_32x32x16_bf16 v[96:111], v[20:23], v[76:79], 0
    s_nop 4
    v_max3_f32 v48, v80, v81, v82
    v_max3_f32 v48, v48, v83, v84
    v_max3_f32 v48, v48, v85, v86
    v_max3_f32 v48, v48, v87, v88
    v_max3_f32 v48, v48, v89, v90
    v_max3_f32 v48, v48, v91, v92
    v_max3_f32 v48, v48, v93, v94
    v_max_f32 v48, v48, v95
    v_mul_f32 v48, s97, v48
    v_pk_fma_f32 v[80:81], v[80:81], s[96:97], v[48:49] op_sel_hi:[1,0,0]
    v_pk_fma_f32 v[82:83], v[82:83], s[96:97], v[48:49] op_sel_hi:[1,0,0]
    v_pk_fma_f32 v[84:85], v[84:85], s[96:97], v[48:49] op_sel_hi:[1,0,0]
    v_pk_fma_f32 v[86:87], v[86:87], s[96:97], v[48:49] op_sel_hi:[1,0,0]
    v_pk_fma_f32 v[88:89], v[88:89], s[96:97], v[48:49] op_sel_hi:[1,0,0]
    v_pk_fma_f32 v[90:91], v[90:91], s[96:97], v[48:49] op_sel_hi:[1,0,0]
    v_pk_fma_f32 v[92:93], v[92:93], s[96:97], v[48:49] op_sel_hi:[1,0,0]
    v_pk_fma_f32 v[94:95], v[94:95], s[96:97], v[48:49] op_sel_hi:[1,0,0]
    v_exp_f32 v80, v80
    v_exp_f32 v81, v81
    v_exp_f32 v82, v82
    v_exp_f32 v83, v83
    v_exp_f32 v84, v84
    v_exp_f32 v85, v85
    v_exp_f32 v86, v86
    v_exp_f32 v87, v87
    v_exp_f32 v88, v88
    v_exp_f32 v89, v89
    v_exp_f32 v90, v90
    v_exp_f32 v91, v91
    v_exp_f32 v92, v92
    s_mov_b32 s76, 0x3f80
    s_mov_b32 s77, 0x3f800000
    v_mov_b32 v43, s86
    s_mov_b64 exec, 0xffff
    s_waitcnt vmcnt(1)
    v_xor_b32 v38, s86, v131
    v_bitop3_b32 v38, v38, s86, v135 bitop3:0xf6
    v_bitop3_b32 v38, v38, s86, v139 bitop3:0xf6
    v_bitop3_b32 v38, v38, s86, v143 bitop3:0xf6
    v_cmp_ne_u32 vcc, 0, v38
    s_cbranch_vccnz L_gr4
L_go5:
    v_lshlrev_b32 v32, 16, v128
    v_and_b32 v33, 0xffff0000, v128
    v_lshlrev_b32 v34, 16, v129
    v_and_b32 v35, 0xffff0000, v129
    v_add_f32 v36, v130, v134
    v_dot2c_f32_bf16 v32, s76, v132
    v_dot2c_f32_bf16 v33, s77, v132
    v_dot2c_f32_bf16 v34, s76, v133
    v_dot2c_f32_bf16 v35, s77, v133
    v_dot2c_f32_bf16 v32, s76, v136
    v_dot2c_f32_bf16 v33, s77, v136
    v_dot2c_f32_bf16 v34, s76, v137
    v_dot2c_f32_bf16 v35, s77, v137
    v_add_f32 v36, v36, v138
    v_dot2c_f32_bf16 v32, s76, v140
    v_dot2c_f32_bf16 v33, s77, v140
    v_dot2c_f32_bf16 v34, s76, v141
    v_dot2c_f32_bf16 v35, s77, v141
    v_add_f32 v36, v36, v142
    s_nop 1
    v_add_f32_dpp v36, v36, v36 row_ror:4 row_mask:0xf bank_mask:0xf
    v_add_f32_dpp v32, v32, v32 row_ror:4 row_mask:0xf bank_mask:0xf
    v_add_f32_dpp v33, v33, v33 row_ror:4 row_mask:0xf bank_mask:0xf
    v_add_f32_dpp v34, v34, v34 row_ror:4 row_mask:0xf bank_mask:0xf
    v_add_f32_dpp v35, v35, v35 row_ror:4 row_mask:0xf bank_mask:0xf
    v_add_f32_dpp v36, v36, v36 row_ror:8 row_mask:0xf bank_mask:0xf
    v_add_f32_dpp v32, v32, v32 row_ror:8 row_mask:0xf bank_mask:0xf
    v_add_f32_dpp v33, v33, v33 row_ror:8 row_mask:0xf bank_mask:0xf
    v_add_f32_dpp v34, v34, v34 row_ror:8 row_mask:0xf bank_mask:0xf
    v_add_f32_dpp v35, v35, v35 row_ror:8 row_mask:0xf bank_mask:0xf
    v_cvt_pk_bf16_f32 v42, v36, v36
    v_cvt_pk_bf16_f32 v40, v32, v33
    v_cvt_pk_bf16_f32 v41, v34, v35
    s_mov_b64 exec, 15
    buffer_store_dwordx4 v[40:43], v3, s[28:31], s73 offen sc1
    s_mov_b64 exec, -1
    v_mov_b32 v12, 0
    s_mov_b64 exec, 0xffff
    buffer_atomic_add v12, v5, s[28:31], s12 offen sc0 sc1
    s_mov_b64 exec, -1
    v_exp_f32 v93, v93
    v_exp_f32 v94, v94
    v_exp_f32 v95, v95
    v_pk_add_f32 v[48:49], v[80:81], v[82:83]
    v_pk_add_f32 v[50:51], v[84:85], v[86:87]
    v_pk_add_f32 v[48:49], v[48:49], v[88:89]
    v_pk_add_f32 v[50:51], v[50:51], v[90:91]
    v_pk_add_f32 v[48:49], v[48:49], v[92:93]
    v_pk_add_f32 v[50:51], v[50:51], v[94:95]
    v_pk_add_f32 v[48:49], v[48:49], v[50:51]
    v_add_f32 v48, v48, v49
    v_rcp_f32 v48, v48
    s_nop 0
    v_pk_mul_f32 v[80:81], v[80:81], v[48:49] op_sel_hi:[1,0]
    v_pk_mul_f32 v[82:83], v[82:83], v[48:49] op_sel_hi:[1,0]
    v_pk_mul_f32 v[84:85], v[84:85], v[48:49] op_sel_hi:[1,0]
    v_pk_mul_f32 v[86:87], v[86:87], v[48:49] op_sel_hi:[1,0]
    v_pk_mul_f32 v[88:89], v[88:89], v[48:49] op_sel_hi:[1,0]
    v_pk_mul_f32 v[90:91], v[90:91], v[48:49] op_sel_hi:[1,0]
    v_pk_mul_f32 v[92:93], v[92:93], v[48:49] op_sel_hi:[1,0]
    v_pk_mul_f32 v[94:95], v[94:95], v[48:49] op_sel_hi:[1,0]
    v_cvt_pk_bf16_f32 v112, v80, v81
    v_cvt_pk_bf16_f32 v113, v82, v83
    v_cvt_pk_bf16_f32 v114, v84, v85
    v_cvt_pk_bf16_f32 v115, v86, v87
    v_cvt_pk_bf16_f32 v116, v88, v89
    v_cvt_pk_bf16_f32 v117, v90, v91
    v_cvt_pk_bf16_f32 v118, v92, v93
    v_cvt_pk_bf16_f32 v119, v94, v95
    v_max3_f32 v48, v96, v97, v98
    v_max3_f32 v48, v48, v99, v100
    v_max3_f32 v48, v48, v101, v102
    v_max3_f32 v48, v48, v103, v104
    v_max3_f32 v48, v48, v105, v106
    v_max3_f32 v48, v48, v107, v108
    v_max3_f32 v48, v48, v109, v110
    v_max_f32 v48, v48, v111
    v_mul_f32 v48, s97, v48
    v_pk_fma_f32 v[96:97], v[96:97], s[96:97], v[48:49] op_sel_hi:[1,0,0]
    v_pk_fma_f32 v[98:99], v[98:99], s[96:97], v[48:49] op_sel_hi:[1,0,0]
    v_pk_fma_f32 v[100:101], v[100:101], s[96:97], v[48:49] op_sel_hi:[1,0,0]
    v_pk_fma_f32 v[102:103], v[102:103], s[96:97], v[48:49] op_sel_hi:[1,0,0]
    v_pk_fma_f32 v[104:105], v[104:105], s[96:97], v[48:49] op_sel_hi:[1,0,0]
    v_pk_fma_f32 v[106:107], v[106:107], s[96:97], v[48:49] op_sel_hi:[1,0,0]
    v_pk_fma_f32 v[108:109], v[108:109], s[96:97], v[48:49] op_sel_hi:[1,0,0]
    v_pk_fma_f32 v[110:111], v[110:111], s[96:97], v[48:49] op_sel_hi:[1,0,0]
    v_exp_f32 v96, v96
    v_exp_f32 v97, v97
    v_exp_f32 v98, v98
    v_exp_f32 v99, v99
    v_exp_f32 v100, v100
    v_exp_f32 v101, v101
    v_exp_f32 v102, v102
    v_exp_f32 v103, v103
    v_exp_f32 v104, v104
    v_exp_f32 v105, v105
    v_exp_f32 v106, v106
    v_exp_f32 v107, v107
    v_exp_f32 v108, v108
    v_exp_f32 v109, v109
    v_exp_f32 v110, v110
    v_exp_f32 v111, v111
    v_pk_add_f32 v[48:49], v[96:97], v[98:99]
    v_pk_add_f32 v[50:51], v[100:101], v[102:103]
    v_pk_add_f32 v[48:49], v[48:49], v[104:105]
    v_pk_add_f32 v[50:51], v[50:51], v[106:107]
    v_pk_add_f32 v[48:49], v[48:49], v[108:109]
    v_pk_add_f32 v[50:51], v[50:51], v[110:111]
    v_pk_add_f32 v[48:49], v[48:49], v[50:51]
    v_add_f32 v48, v48, v49
    v_rcp_f32 v48, v48
    s_nop 0
    v_pk_mul_f32 v[96:97], v[96:97], v[48:49] op_sel_hi:[1,0]
    v_pk_mul_f32 v[98:99], v[98:99], v[48:49] op_sel_hi:[1,0]
    v_pk_mul_f32 v[100:101], v[100:101], v[48:49] op_sel_hi:[1,0]
    v_pk_mul_f32 v[102:103], v[102:103], v[48:49] op_sel_hi:[1,0]
    v_pk_mul_f32 v[104:105], v[104:105], v[48:49] op_sel_hi:[1,0]
    v_pk_mul_f32 v[106:107], v[106:107], v[48:49] op_sel_hi:[1,0]
    v_pk_mul_f32 v[108:109], v[108:109], v[48:49] op_sel_hi:[1,0]
    v_pk_mul_f32 v[110:111], v[110:111], v[48:49] op_sel_hi:[1,0]
    v_cvt_pk_bf16_f32 v120, v96, v97
    v_cvt_pk_bf16_f32 v121, v98, v99
    v_cvt_pk_bf16_f32 v122, v100, v101
    v_cvt_pk_bf16_f32 v123, v102, v103
    v_cvt_pk_bf16_f32 v124, v104, v105
    v_cvt_pk_bf16_f32 v125, v106, v107
    v_cvt_pk_bf16_f32 v126, v108, v109
    v_cvt_pk_bf16_f32 v127, v110, v111
L_rs8:
    ds_read_b128 v[32:35], v2
    s_waitcnt lgkmcnt(0)
    v_min3_u32 v32, v32, v33, v34
    v_min_u32 v32, v32, v35
    v_cmp_gt_u32 vcc, 4, v32
    s_cbranch_vccnz L_rs8
    s_add_u32 m0, s74, 98304
    s_mov_b32 s55, 262144
    buffer_load_dwordx4 v6, s[8:11], s55 offen offset:0 lds
    buffer_load_dwordx4 v7, s[8:11], s55 offen offset:1024 lds
    buffer_load_dwordx4 v8, s[8:11], s55 offen offset:2048 lds
    buffer_load_dwordx4 v9, s[8:11], s55 offen offset:3072 lds
    s_add_u32 m0, s74, 102400
    s_mov_b32 s55, 294912
    buffer_load_dwordx4 v6, s[8:11], s55 offen offset:0 lds
    buffer_load_dwordx4 v7, s[8:11], s55 offen offset:1024 lds
    buffer_load_dwordx4 v8, s[8:11], s55 offen offset:2048 lds
    buffer_load_dwordx4 v9, s[8:11], s55 offen offset:3072 lds
    s_lshl_b32 s94, s90, 3
    s_add_u32 s94, s94, 156672
    v_lshlrev_b32 v106, 5, v0
    v_add_u32 v102, s94, v106
    v_add_u32 v106, 156672, v106
    v_bfe_u32 v103, v0, 4, 1
    v_lshlrev_b32 v103, 5, v103
    v_lshrrev_b32 v107, 5, v0
    v_lshl_add_u32 v103, v107, 3, v103
    v_bfe_u32 v107, v0, 2, 2
    v_lshl_add_u32 v103, v107, 1, v103
    s_lshr_b32 s94, s90, 1
    s_lshl_b32 s94, s94, 6
    s_and_b32 s95, s90, 1
    s_lshl_b32 s95, s95, 4
    s_add_u32 s94, s94, s95
    s_add_u32 s94, s94, 138240
    v_add_u32 v103, s94, v103
    v_and_b32 v107, 32, v0
    v_add_u32 v107, 138240, v107
    v_cndmask_b32 v104, v107, v106, s[98:99]
    v_add_u32 v107, 64, v107
    v_cndmask_b32 v105, v106, v107, s[98:99]
    s_lshl_b32 s94, s88, 2
    s_add_u32 s94, s94, s90
    s_lshl_b32 s94, s94, 8
    s_lshr_b32 s95, s89, 3
    s_lshl_b32 s95, s95, 7
    s_add_u32 s94, s94, s95
    s_and_b32 s95, s89, 7
    s_lshl_b32 s95, s95, 3
    s_add_u32 s94, s94, s95
    s_add_u32 s13, s94, 36864
    s_mov_b32 s96, 0x3f80
    s_mov_b32 s97, 0x3f800000
    s_waitcnt vmcnt(8)
    v_cmp_ne_u32 vcc, s86, v12
    s_nop 0
    s_and_b64 vcc, vcc, 0xffff
    s_cbranch_scc0 L_pd10
    s_mov_b32 s94, 20000
L_pl9:
    s_sleep 2
    v_mov_b32 v12, 0
    s_mov_b64 exec, 0xffff
    buffer_atomic_add v12, v5, s[28:31], s12 offen sc0 sc1
    s_mov_b64 exec, -1
    s_sub_u32 s94, s94, 1
    s_waitcnt vmcnt(0)
    s_cbranch_scc1 L_pd10
    v_cmp_ne_u32 vcc, s86, v12
    s_nop 0
    s_and_b64 vcc, vcc, 0xffff
    s_cbranch_scc1 L_pl9
    s_sleep 4
L_pd10:
    buffer_load_dwordx4 v[68:71], v3, s[28:31], s71 offen sc1
    s_waitcnt vmcnt(0)
    v_cmp_ne_u32 vcc, s86, v71
    s_cbranch_vccnz L_gr11
L_go12:
    ds_write_b64 v102, v[68:69]
    ds_write_b16 v103, v70
    v_mov_b32 v36, 5
    s_mov_b64 exec, 1
    ds_write_b32 v1, v36
    s_mov_b64 exec, -1
L_rs15:
    ds_read_b128 v[36:39], v2
    s_waitcnt lgkmcnt(0)
    v_min3_u32 v36, v36, v37, v38
    v_min_u32 v36, v36, v39
    v_cmp_gt_u32 vcc, 5, v36
    s_cbranch_vccnz L_rs15
    ds_read_b128 v[32:35], v104 offset:0
    ds_read_b128 v[40:43], v105 offset:0
    ds_read_b128 v[36:39], v104 offset:16
    ds_read_b128 v[44:47], v105 offset:16
    s_mov_b32 s95, 0x358637bd
    v_lshlrev_b32 v21, 3, v0
    s_waitcnt lgkmcnt(3)
    v_mfma_f32_32x32x16_bf16 v[48:63], v[32:35], v[112:115], 0
    s_waitcnt lgkmcnt(1)
    v_mfma_f32_32x32x16_bf16 v[48:63], v[36:39], v[116:119], v[48:63]
    v_mfma_f32_32x32x16_bf16 v[64:79], v[40:43], v[120:123], 0
    s_waitcnt lgkmcnt(0)
    v_mfma_f32_32x32x16_bf16 v[64:79], v[44:47], v[124:127], v[64:79]
    s_lshr_b32 s94, s89, 3
    s_lshl_b32 s94, s94, 1
    s_and_b32 s96, s90, 1
    s_add_u32 s94, s94, s96
    s_lshr_b32 s96, s90, 1
    s_lshl_b32 s96, s96, 3
    s_lshl_b32 s70, s88, 2
    s_add_u32 s70, s70, s94
    s_lshl_b32 s70, s70, 4
    s_add_u32 s70, s70, s96
    s_lshl_b32 s12, s70, 4
    s_add_u32 s12, s12, 36864
    v_add_f32 v56, s95, v56
    v_rcp_f32 v56, v56
    s_nop 0
    v_mul_f32 v48, v48, v56
    v_mul_f32 v49, v49, v56
    v_mul_f32 v50, v50, v56
    v_mul_f32 v51, v51, v56
    v_mul_f32 v52, v52, v56
    v_mul_f32 v53, v53, v56
    v_mul_f32 v54, v54, v56
    v_mul_f32 v55, v55, v56
    v_cvt_pk_bf16_f32 v80, v48, v49
    v_cvt_pk_bf16_f32 v81, v50, v51
    v_cvt_pk_bf16_f32 v82, v52, v53
    v_cvt_pk_bf16_f32 v83, v54, v55
    buffer_store_dwordx4 v[80:83], v3, s[28:31], s75 offen offset:0 sc1
    v_add_f32 v64, s95, v64
    v_rcp_f32 v64, v64
    s_nop 0
    v_mul_f32 v72, v72, v64
    v_mul_f32 v73, v73, v64
    v_mul_f32 v74, v74, v64
    v_mul_f32 v75, v75, v64
    v_mul_f32 v76, v76, v64
    v_mul_f32 v77, v77, v64
    v_mul_f32 v78, v78, v64
    v_mul_f32 v79, v79, v64
    v_cvt_pk_bf16_f32 v84, v72, v73
    v_cvt_pk_bf16_f32 v85, v74, v75
    v_cvt_pk_bf16_f32 v86, v76, v77
    v_cvt_pk_bf16_f32 v87, v78, v79
    buffer_store_dwordx4 v[84:87], v3, s[28:31], s75 offen offset:1024 sc1
    s_add_u32 m0, s74, 65536
    s_mov_b32 s55, 0
    buffer_load_dwordx4 v6, s[8:11], s55 offen offset:0 lds
    buffer_load_dwordx4 v7, s[8:11], s55 offen offset:1024 lds
    buffer_load_dwordx4 v8, s[8:11], s55 offen offset:2048 lds
    buffer_load_dwordx4 v9, s[8:11], s55 offen offset:3072 lds
    s_add_u32 m0, s74, 69632
    s_mov_b32 s55, 32768
    buffer_load_dwordx4 v6, s[8:11], s55 offen offset:0 lds
    buffer_load_dwordx4 v7, s[8:11], s55 offen offset:1024 lds
    buffer_load_dwordx4 v8, s[8:11], s55 offen offset:2048 lds
    buffer_load_dwordx4 v9, s[8:11], s55 offen offset:3072 lds
    s_mul_i32 s70, s70, 2048
    s_add_u32 s70, s70, 7340032
    s_mov_b32 s84, s86
    s_mov_b32 s85, s86
    v_lshrrev_b32 v96, 5, v0
    v_bfe_u32 v97, v0, 2, 2
    v_lshl_add_u32 v96, v96, 3, v97
    v_lshlrev_b32 v96, 7, v96
    v_bfe_u32 v97, v0, 3, 1
    v_lshl_add_u32 v96, v97, 6, v96
    v_bfe_u32 v97, v0, 4, 1
    v_lshl_add_u32 v96, v97, 5, v96
    v_and_b32 v97, 3, v0
    v_lshl_add_u32 v96, v97, 3, v96
    s_lshr_b32 s94, s90, 1
    s_lshl_b32 s94, s94, 15
    s_add_u32 s94, s94, 65536
    v_add_u32 v96, s94, v96
    v_xor_b32 v97, 64, v96
    s_waitcnt vmcnt(8)
    v_mov_b32 v34, s86
    v_mov_b32 v35, s87
    s_mov_b64 exec, 1
    buffer_store_dwordx2 v[34:35], off, s[28:31], s13 sc1
    s_mov_b64 exec, -1
    s_lshr_b32 s95, s89, 3
    s_lshl_b32 s94, s88, 7
    s_lshl_b32 s95, s95, 6
    s_add_u32 s94, s94, s95
    s_lshr_b32 s95, s3, 2
    s_lshl_b32 s95, s95, 5
    s_add_u32 s94, s94, s95
    s_lshl_b32 s95, s90, 2
    s_add_u32 s94, s94, s95
    s_lshl_b32 s94, s94, 10
    s_and_b32 s95, s89, 7
    s_lshl_b32 s95, s95, 7
    v_and_b32 v34, 15, v0
    v_lshlrev_b32 v34, 3, v34
    v_add_u32 v34, s95, v34
    v_lshrrev_b32 v5, 4, v0
    v_lshl_add_u32 v5, v5, 10, v34
    v_add_u32 v5, s94, v5
    v_add_u32 v35, 0x4000, v5
    global_load_dwordx2 v[10:11], v5, s[36:37]
    global_load_dwordx2 v[12:13], v35, s[36:37]
    global_load_dwordx2 v[14:15], v34, s[52:53]
    s_waitcnt vmcnt(4)
    v_mov_b32 v100, 6
    s_mov_b64 exec, 1
    ds_write_b32 v1, v100
    s_mov_b64 exec, -1
L_rs16:
    ds_read_b128 v[100:103], v2
    s_waitcnt lgkmcnt(0)
    v_min3_u32 v100, v100, v101, v102
    v_min_u32 v100, v100, v103
    v_cmp_gt_u32 vcc, 6, v100
    s_cbranch_vccnz L_rs16
    ds_read_b64_tr_b16 v[128:129], v96 offset:0
    ds_read_b64_tr_b16 v[130:131], v96 offset:512
    ds_read_b64_tr_b16 v[132:133], v97 offset:0
    ds_read_b64_tr_b16 v[134:135], v97 offset:512
    ds_read_b64_tr_b16 v[136:137], v96 offset:2048
    ds_read_b64_tr_b16 v[138:139], v96 offset:2560
    ds_read_b64_tr_b16 v[140:141], v97 offset:2048
    ds_read_b64_tr_b16 v[142:143], v97 offset:2560
    ds_read_b64_tr_b16 v[144:145], v96 offset:4096
    ds_read_b64_tr_b16 v[146:147], v96 offset:4608
    ds_read_b64_tr_b16 v[148:149], v97 offset:4096
    ds_read_b64_tr_b16 v[150:151], v97 offset:4608
    ds_read_b64_tr_b16 v[152:153], v96 offset:6144
    ds_read_b64_tr_b16 v[154:155], v96 offset:6656
    ds_read_b64_tr_b16 v[156:157], v97 offset:6144
    ds_read_b64_tr_b16 v[158:159], v97 offset:6656
    ds_read_b64_tr_b16 v[160:161], v96 offset:8192
    ds_read_b64_tr_b16 v[162:163], v96 offset:8704
    ds_read_b64_tr_b16 v[164:165], v97 offset:8192
    ds_read_b64_tr_b16 v[166:167], v97 offset:8704
    ds_read_b64_tr_b16 v[168:169], v96 offset:10240
    ds_read_b64_tr_b16 v[170:171], v96 offset:10752
    ds_read_b64_tr_b16 v[172:173], v97 offset:10240
    ds_read_b64_tr_b16 v[174:175], v97 offset:10752
    ds_read_b64_tr_b16 v[176:177], v96 offset:12288
    ds_read_b64_tr_b16 v[178:179], v96 offset:12800
    ds_read_b64_tr_b16 v[180:181], v97 offset:12288
    ds_read_b64_tr_b16 v[182:183], v97 offset:12800
    ds_read_b64_tr_b16 v[184:185], v96 offset:14336
    ds_read_b64_tr_b16 v[186:187], v96 offset:14848
    ds_read_b64_tr_b16 v[188:189], v97 offset:14336
    ds_read_b64_tr_b16 v[190:191], v97 offset:14848
    ds_read_b64_tr_b16 v[192:193], v96 offset:16384
    ds_read_b64_tr_b16 v[194:195], v96 offset:16896
    ds_read_b64_tr_b16 v[196:197], v97 offset:16384
    ds_read_b64_tr_b16 v[198:199], v97 offset:16896
    ds_read_b64_tr_b16 v[200:201], v96 offset:18432
    ds_read_b64_tr_b16 v[202:203], v96 offset:18944
    ds_read_b64_tr_b16 v[204:205], v97 offset:18432
    ds_read_b64_tr_b16 v[206:207], v97 offset:18944
    ds_read_b64_tr_b16 v[208:209], v96 offset:20480
    ds_read_b64_tr_b16 v[210:211], v96 offset:20992
    ds_read_b64_tr_b16 v[212:213], v97 offset:20480
    ds_read_b64_tr_b16 v[214:215], v97 offset:20992
    ds_read_b64_tr_b16 v[216:217], v96 offset:22528
    ds_read_b64_tr_b16 v[218:219], v96 offset:23040
    ds_read_b64_tr_b16 v[220:221], v97 offset:22528
    ds_read_b64_tr_b16 v[222:223], v97 offset:23040
    ds_read_b64_tr_b16 v[224:225], v96 offset:24576
    ds_read_b64_tr_b16 v[226:227], v96 offset:25088
    ds_read_b64_tr_b16 v[228:229], v97 offset:24576
    ds_read_b64_tr_b16 v[230:231], v97 offset:25088
    ds_read_b64_tr_b16 v[232:233], v96 offset:26624
    ds_read_b64_tr_b16 v[234:235], v96 offset:27136
    ds_read_b64_tr_b16 v[236:237], v97 offset:26624
    ds_read_b64_tr_b16 v[238:239], v97 offset:27136
    ds_read_b64_tr_b16 v[240:241], v96 offset:28672
    ds_read_b64_tr_b16 v[242:243], v96 offset:29184
    ds_read_b64_tr_b16 v[244:245], v97 offset:28672
    ds_read_b64_tr_b16 v[246:247], v97 offset:29184
    ds_read_b64_tr_b16 v[248:249], v96 offset:30720
    ds_read_b64_tr_b16 v[250:251], v96 offset:31232
    ds_read_b64_tr_b16 v[252:253], v97 offset:30720
    ds_read_b64_tr_b16 v[254:255], v97 offset:31232
    v_mov_b32 v100, 7
    s_mov_b64 exec, 1
    ds_write_b32 v1, v100
    s_mov_b64 exec, -1
    s_lshl_b32 s94, s90, 13
    s_add_u32 s94, s94, 65536
    v_and_b32 v36, 31, v0
    v_lshlrev_b32 v6, 8, v36
    v_and_b32 v36, 7, v0
    v_lshrrev_b32 v37, 5, v0
    v_xor_b32 v36, v36, v37
    v_lshl_add_u32 v6, v36, 4, v6
    v_add_u32 v6, s94, v6
    v_xor_b32 v7, 32, v6
    v_xor_b32 v8, 64, v6
    v_xor_b32 v9, 96, v6
    v_mov_b32 v104, 0
    v_mov_b32 v105, 0
    s_mov_b64 exec, 0xff
    buffer_atomic_add_x2 v[104:105], v21, s[28:31], s12 offen sc0 sc1
    s_mov_b64 exec, -1
    s_mov_b32 s32, s64
    s_mov_b32 s33, s65
    s_mov_b32 s34, 4194304
    s_mov_b32 s35, 0x20000
    v_lshrrev_b32 v16, 4, v0
    v_and_b32 v17, 15, v0
    v_xor_b32 v17, v17, v16
    v_lshlrev_b32 v17, 4, v17
    v_lshl_add_u32 v17, v16, 8, v17
    s_lshl_b32 s94, s3, 11
    v_add_u32 v17, s94, v17
    v_xor_b32 v18, 64, v17
    v_add_u32 v19, 65536, v17
    v_add_u32 v20, 65536, v18
    s_lshl_b32 s94, s3, 5
    s_add_u32 s94, s94, 131584
    v_lshl_add_u32 v16, v16, 2, s94
    v_lshlrev_b32 v5, 1, v5
    s_waitcnt vmcnt(1)
    v_lshlrev_b32 v30, 16, v14
    v_and_b32 v31, 0xffff0000, v14
    v_lshlrev_b32 v22, 16, v10
    v_and_b32 v23, 0xffff0000, v10
    v_mul_f32 v22, v22, v30
    v_mul_f32 v23, v23, v31
    v_lshlrev_b32 v26, 16, v12
    v_and_b32 v27, 0xffff0000, v12
    v_mul_f32 v26, v26, v30
    v_mul_f32 v27, v27, v31
    v_lshlrev_b32 v30, 16, v15
    v_and_b32 v31, 0xffff0000, v15
    v_lshlrev_b32 v24, 16, v11
    v_and_b32 v25, 0xffff0000, v11
    v_mul_f32 v24, v24, v30
    v_mul_f32 v25, v25, v31
    v_lshlrev_b32 v28, 16, v13
    v_and_b32 v29, 0xffff0000, v13
    v_mul_f32 v28, v28, v30
    v_mul_f32 v29, v29, v31
    s_setprio 0
    s_waitcnt vmcnt(0)
    v_cmp_ne_u64 vcc, s[86:87], v[104:105]
    s_nop 0
    s_and_b64 vcc, vcc, 0xff
    s_cbranch_scc0 L_pd18
    s_mov_b32 s94, 20000
L_pl17:
    s_sleep 2
    v_mov_b32 v104, 0
    v_mov_b32 v105, 0
    s_mov_b64 exec, 0xff
    buffer_atomic_add_x2 v[104:105], v21, s[28:31], s12 offen sc0 sc1
    s_mov_b64 exec, -1
    s_sub_u32 s94, s94, 1
    s_waitcnt vmcnt(0)
    s_cbranch_scc1 L_pd18
    v_cmp_ne_u64 vcc, s[86:87], v[104:105]
    s_nop 0
    s_and_b64 vcc, vcc, 0xff
    s_cbranch_scc1 L_pl17
L_pd18:
    buffer_load_dwordx4 v[32:35], v3, s[28:31], s70 offen offset:0 sc1
    buffer_load_dwordx4 v[36:39], v3, s[28:31], s70 offen offset:1024 sc1
    buffer_load_dwordx4 v[40:43], v3, s[28:31], s70 offen offset:2048 sc1
    buffer_load_dwordx4 v[44:47], v3, s[28:31], s70 offen offset:3072 sc1
    s_add_u32 s70, s70, 4096
    buffer_load_dwordx4 v[48:51], v3, s[28:31], s70 offen offset:0 sc1
    buffer_load_dwordx4 v[52:55], v3, s[28:31], s70 offen offset:1024 sc1
    buffer_load_dwordx4 v[56:59], v3, s[28:31], s70 offen offset:2048 sc1
    buffer_load_dwordx4 v[60:63], v3, s[28:31], s70 offen offset:3072 sc1
    s_add_u32 s70, s70, 4096
    buffer_load_dwordx4 v[64:67], v3, s[28:31], s70 offen offset:0 sc1
    buffer_load_dwordx4 v[68:71], v3, s[28:31], s70 offen offset:1024 sc1
    buffer_load_dwordx4 v[72:75], v3, s[28:31], s70 offen offset:2048 sc1
    buffer_load_dwordx4 v[76:79], v3, s[28:31], s70 offen offset:3072 sc1
    s_add_u32 s70, s70, 4096
    buffer_load_dwordx4 v[80:83], v3, s[28:31], s70 offen offset:0 sc1
    buffer_load_dwordx4 v[84:87], v3, s[28:31], s70 offen offset:1024 sc1
    buffer_load_dwordx4 v[88:91], v3, s[28:31], s70 offen offset:2048 sc1
    buffer_load_dwordx4 v[92:95], v3, s[28:31], s70 offen offset:3072 sc1
L_rs19:
    ds_read_b128 v[100:103], v2
    s_waitcnt lgkmcnt(0)
    v_min3_u32 v100, v100, v101, v102
    v_min_u32 v100, v100, v103
    v_cmp_gt_u32 vcc, 7, v100
    s_cbranch_vccnz L_rs19
    s_waitcnt vmcnt(15)
    v_mfma_f32_32x32x16_bf16 v[96:111], v[128:131], v[32:35], 0
    v_mfma_f32_32x32x16_bf16 v[112:127], v[132:135], v[32:35], 0
    s_waitcnt vmcnt(14)
    v_mfma_f32_32x32x16_bf16 v[96:111], v[136:139], v[36:39], v[96:111]
    v_mfma_f32_32x32x16_bf16 v[112:127], v[140:143], v[36:39], v[112:127]
    s_waitcnt vmcnt(13)
    v_mfma_f32_32x32x16_bf16 v[96:111], v[144:147], v[40:43], v[96:111]
    v_mfma_f32_32x32x16_bf16 v[112:127], v[148:151], v[40:43], v[112:127]
    s_waitcnt vmcnt(12)
    v_mfma_f32_32x32x16_bf16 v[96:111], v[152:155], v[44:47], v[96:111]
    v_mfma_f32_32x32x16_bf16 v[112:127], v[156:159], v[44:47], v[112:127]
    s_waitcnt vmcnt(11)
    v_mfma_f32_32x32x16_bf16 v[96:111], v[160:163], v[48:51], v[96:111]
    v_mfma_f32_32x32x16_bf16 v[112:127], v[164:167], v[48:51], v[112:127]
    s_waitcnt vmcnt(10)
    v_mfma_f32_32x32x16_bf16 v[96:111], v[168:171], v[52:55], v[96:111]
    v_mfma_f32_32x32x16_bf16 v[112:127], v[172:175], v[52:55], v[112:127]
    s_waitcnt vmcnt(9)
    v_mfma_f32_32x32x16_bf16 v[96:111], v[176:179], v[56:59], v[96:111]
    v_mfma_f32_32x32x16_bf16 v[112:127], v[180:183], v[56:59], v[112:127]
    s_waitcnt vmcnt(8)
    v_mfma_f32_32x32x16_bf16 v[96:111], v[184:187], v[60:63], v[96:111]
    v_mfma_f32_32x32x16_bf16 v[112:127], v[188:191], v[60:63], v[112:127]
    s_waitcnt vmcnt(7)
    v_mfma_f32_32x32x16_bf16 v[96:111], v[192:195], v[64:67], v[96:111]
    v_mfma_f32_32x32x16_bf16 v[112:127], v[196:199], v[64:67], v[112:127]
    s_waitcnt vmcnt(6)
    v_mfma_f32_32x32x16_bf16 v[96:111], v[200:203], v[68:71], v[96:111]
    v_mfma_f32_32x32x16_bf16 v[112:127], v[204:207], v[68:71], v[112:127]
    s_waitcnt vmcnt(5)
    v_mfma_f32_32x32x16_bf16 v[96:111], v[208:211], v[72:75], v[96:111]
    v_mfma_f32_32x32x16_bf16 v[112:127], v[212:215], v[72:75], v[112:127]
    s_waitcnt vmcnt(4)
    v_mfma_f32_32x32x16_bf16 v[96:111], v[216:219], v[76:79], v[96:111]
    v_mfma_f32_32x32x16_bf16 v[112:127], v[220:223], v[76:79], v[112:127]
    s_waitcnt vmcnt(3)
    v_mfma_f32_32x32x16_bf16 v[96:111], v[224:227], v[80:83], v[96:111]
    v_mfma_f32_32x32x16_bf16 v[112:127], v[228:231], v[80:83], v[112:127]
    s_waitcnt vmcnt(2)
    v_mfma_f32_32x32x16_bf16 v[96:111], v[232:235], v[84:87], v[96:111]
    v_mfma_f32_32x32x16_bf16 v[112:127], v[236:239], v[84:87], v[112:127]
    s_waitcnt vmcnt(1)
    v_mfma_f32_32x32x16_bf16 v[96:111], v[240:243], v[88:91], v[96:111]
    v_mfma_f32_32x32x16_bf16 v[112:127], v[244:247], v[88:91], v[112:127]
    s_waitcnt vmcnt(0)
    v_mfma_f32_32x32x16_bf16 v[96:111], v[248:251], v[92:95], v[96:111]
    v_mfma_f32_32x32x16_bf16 v[112:127], v[252:255], v[92:95], v[112:127]
    s_nop 10
    ds_write_b128 v6, v[96:99] offset:0
    ds_write_b128 v7, v[100:103] offset:0
    ds_write_b128 v8, v[104:107] offset:0
    ds_write_b128 v9, v[108:111] offset:0
    ds_write_b128 v6, v[112:115] offset:128
    ds_write_b128 v7, v[116:119] offset:128
    ds_write_b128 v8, v[120:123] offset:128
    ds_write_b128 v9, v[124:127] offset:128
    s_branch L_final
L_role_cold:
L_gr4:
    s_mov_b32 s94, 20000
L_gq6:
    s_sleep 4
    buffer_load_dwordx4 v[128:131], v3, s[28:31], s70 offen offset:0 sc1
    buffer_load_dwordx4 v[132:135], v3, s[28:31], s70 offen offset:256 sc1
    buffer_load_dwordx4 v[136:139], v3, s[28:31], s70 offen offset:512 sc1
    buffer_load_dwordx4 v[140:143], v3, s[28:31], s70 offen offset:768 sc1
    s_sub_u32 s94, s94, 1
    s_waitcnt vmcnt(0)
    s_cbranch_scc1 L_go5
    v_xor_b32 v38, s86, v131
    v_bitop3_b32 v38, v38, s86, v135 bitop3:0xf6
    v_bitop3_b32 v38, v38, s86, v139 bitop3:0xf6
    v_bitop3_b32 v38, v38, s86, v143 bitop3:0xf6
    v_cmp_ne_u32 vcc, 0, v38
    s_cbranch_vccnz L_gq6
    s_branch L_go5
L_role_c7:
L_gr11:
    s_mov_b32 s94, 20000
L_gq13:
    s_sleep 4
    buffer_load_dwordx4 v[68:71], v3, s[28:31], s71 offen sc1
    s_sub_u32 s94, s94, 1
    s_waitcnt vmcnt(0)
    s_cbranch_scc1 L_go12
    v_cmp_ne_u32 vcc, s86, v71
    s_cbranch_vccnz L_gq13
    s_branch L_go12
L_role_c14:
L_role_Smain:
    s_setprio 0
    s_mov_b32 s28, s68
    s_mov_b32 s29, s69
    s_mov_b32 s30, 16777216
    s_mov_b32 s31, 0x20000
    s_lshl_b32 s94, s3, 2
    s_add_u32 s94, s94, 131072
    v_mov_b32 v1, s94
    s_and_b32 s94, s94, 0xfffffff0
    v_mov_b32 v2, s94
    v_bfe_u32 v104, v0, 3, 2
    v_and_b32 v105, 3, v0
    v_lshl_add_u32 v104, v104, 2, v105
    v_bfe_u32 v105, v0, 2, 1
    v_lshrrev_b32 v106, 5, v0
    v_xor_b32 v105, v105, v106
    v_lshl_add_u32 v104, v105, 4, v104
    v_and_b32 v105, 1, v0
    v_lshlrev_b32 v105, 4, v105
    v_mov_b32 v106, 0x3f80
    v_lshlrev_b32 v105, v105, v106
    v_lshrrev_b32 v104, 1, v104
    v_cmp_eq_u32 vcc, 0, v104
    s_nop 1
    v_cndmask_b32 v40, 0, v105, vcc
    v_cmp_eq_u32 vcc, 1, v104
    s_nop 1
    v_cndmask_b32 v41, 0, v105, vcc
    v_cmp_eq_u32 vcc, 2, v104
    s_nop 1
    v_cndmask_b32 v42, 0, v105, vcc
    v_cmp_eq_u32 vcc, 3, v104
    s_nop 1
    v_cndmask_b32 v43, 0, v105, vcc
    v_cmp_eq_u32 vcc, 4, v104
    s_nop 1
    v_cndmask_b32 v44, 0, v105, vcc
    v_cmp_eq_u32 vcc, 5, v104
    s_nop 1
    v_cndmask_b32 v45, 0, v105, vcc
    v_cmp_eq_u32 vcc, 6, v104
    s_nop 1
    v_cndmask_b32 v46, 0, v105, vcc
    v_cmp_eq_u32 vcc, 7, v104
    s_nop 1
    v_cndmask_b32 v47, 0, v105, vcc
    s_lshl_b32 s94, s90, 9
    s_add_u32 s94, s94, 134144
    v_lshl_add_u32 v34, v0, 3, s94
    v_mov_b32 v104, 0
    v_mov_b32 v105, 0
    ds_write_b64 v34, v[104:105]
    v_mov_b32 v104, 0
    s_mov_b64 exec, 1
    ds_write_b32 v1, v104
    s_mov_b64 exec, -1
    v_and_b32 v35, 31, v0
    v_lshlrev_b32 v35, 3, v35
    v_lshrrev_b32 v106, 5, v0
    s_lshl_b32 s94, s90, 2
    v_add_u32 v107, s94, v106
    v_add_u32 v108, 2, v107
    s_lshl_b32 s94, s89, 13
    s_add_u32 s94, s94, 65536
    v_lshl_add_u32 v109, v35, 1, s94
    v_mov_b32 v110, 0x7ffffff0
    v_cmp_gt_u32 s[78:79], s88, v107
    v_lshl_add_u32 v32, v107, 9, v109
    s_nop 0
    v_cndmask_b32 v32, v110, v32, s[78:79]
    v_sub_u32 v107, s88, v107
    v_add_u32 v107, -1, v107
    v_max_i32 v107, 0, v107
    v_lshlrev_b32 v107, 7, v107
    v_cvt_f32_u32 v107, v107
    v_cmp_gt_u32 s[80:81], s88, v108
    v_lshl_add_u32 v33, v108, 9, v109
    s_nop 0
    v_cndmask_b32 v33, v110, v33, s[80:81]
    v_sub_u32 v108, s88, v108
    v_add_u32 v108, -1, v108
    v_max_i32 v108, 0, v108
    v_lshlrev_b32 v108, 7, v108
    v_cvt_f32_u32 v108, v108
    s_lshl_b32 s94, s90, 1
    v_add_u32 v106, s94, v106
    v_lshlrev_b32 v106, 4, v106
    v_cvt_f32_u32 v106, v106
    s_mov_b32 s96, 1069066811
    s_and_b32 s94, s89, 7
    s_lshl_b32 s94, s94, 16
    s_lshl_b32 s95, s90, 8
    s_add_u32 s94, s94, s95
    s_add_u32 s8, s46, s94
    s_addc_u32 s9, s47, 0
    s_sub_u32 s10, 524288, s94
    s_mov_b32 s11, 0x20000
    s_add_u32 s12, s48, s94
    s_addc_u32 s13, s49, 0
    s_sub_u32 s14, 524288, s94
    s_mov_b32 s15, 0x20000
    s_lshl_b32 s93, s90, 14
    s_add_u32 s93, s93, 0
    v_lshrrev_b32 v36, 3, v0
    v_lshlrev_b32 v36, 10, v36
    v_and_b32 v109, 7, v0
    v_lshrrev_b32 v110, 4, v0
    v_xor_b32 v109, v109, v110
    v_lshl_add_u32 v36, v109, 4, v36
    v_xor_b32 v37, 64, v36
    v_add_u32 v38, 14336, v36
    v_add_u32 v39, 21504, v37
    v_add_u32 v37, 7168, v37
    s_lshl_b32 s94, s89, 4
    s_add_u32 s94, s94, s88
    s_lshl_b32 s94, s94, 9
    s_add_u32 s82, s94, 65536
    s_lshl_b32 s94, s88, 2
    s_add_u32 s94, s94, s90
    s_lshl_b32 s94, s94, 4
    s_add_u32 s94, s94, s89
    s_mul_i32 s94, s94, 4608
    s_add_u32 s83, s94, 2097152
    v_lshlrev_b32 v5, 2, v0
    s_lshl_b32 s94, s89, 9
    s_add_u32 s94, s94, 4096
    s_lshl_b32 s95, s90, 7
    s_add_u32 s17, s94, s95
    s_lshr_b32 s95, s88, 2
    s_lshl_b32 s95, s95, 7
    s_add_u32 s94, s94, s95
    s_and_b32 s95, s88, 3
    s_lshl_b32 s95, s95, 2
    s_add_u32 s16, s94, s95
    s_lshl_b32 s94, s90, 2
    s_sub_i32 s94, s88, s94
    s_max_i32 s94, s94, 0
    s_min_i32 s94, s94, 4
    s_bfm_b64 s[18:19], s94, 0
    s_waitcnt lgkmcnt(0)
    s_barrier
    ds_read_b128 v[128:131], v12 offset:32768
    ds_read_b128 v[132:135], v6 offset:0
    ds_read_b128 v[136:139], v6 offset:4096
    ds_read_b128 v[140:143], v13 offset:32768
    ds_read_b128 v[144:147], v7 offset:0
    ds_read_b128 v[148:151], v7 offset:4096
    ds_read_b128 v[152:155], v14 offset:32768
    ds_read_b128 v[156:159], v8 offset:0
    ds_read_b128 v[160:163], v8 offset:4096
    ds_read_b128 v[164:167], v15 offset:32768
    ds_read_b128 v[168:171], v9 offset:0
    ds_read_b128 v[172:175], v9 offset:4096
    s_waitcnt vmcnt(0)
    v_readfirstlane_b32 s54, v114
    s_nop 0
    s_mul_i32 s86, s54, 1664525
    s_add_u32 s86, s86, 1013904223
    s_mul_i32 s87, s54, 22695477
    s_add_u32 s87, s87, 0x9e3779b9
    s_waitcnt lgkmcnt(0)
    s_barrier
    v_mfma_f32_32x32x16_bf16 v[48:63], v[128:131], v[132:135], 0
    ds_read_b128 v[176:179], v12 offset:49152
    ds_read_b128 v[180:183], v6 offset:8192
    ds_read_b128 v[184:187], v6 offset:12288
    v_mfma_f32_32x32x16_bf16 v[64:79], v[128:131], v[136:139], 0
    ds_read_b128 v[188:191], v13 offset:49152
    ds_read_b128 v[192:195], v7 offset:8192
    ds_read_b128 v[196:199], v7 offset:12288
    v_mfma_f32_32x32x16_bf16 v[48:63], v[140:143], v[144:147], v[48:63]
    ds_read_b128 v[200:203], v14 offset:49152
    ds_read_b128 v[204:207], v8 offset:8192
    ds_read_b128 v[208:211], v8 offset:12288
    v_mfma_f32_32x32x16_bf16 v[64:79], v[140:143], v[148:151], v[64:79]
    ds_read_b128 v[212:215], v15 offset:49152
    ds_read_b128 v[216:219], v9 offset:8192
    ds_read_b128 v[220:223], v9 offset:12288
    v_mfma_f32_32x32x16_bf16 v[48:63], v[152:155], v[156:159], v[48:63]
    v_lshlrev_b32 v100, 16, v100
    v_lshlrev_b32 v101, 16, v101
    v_lshlrev_b32 v102, 16, v102
    v_mul_f32 v100, s96, v100
    v_mfma_f32_32x32x16_bf16 v[64:79], v[152:155], v[160:163], v[64:79]
    v_exp_f32 v100, v100
    s_nop 0
    v_cvt_pk_bf16_f32 v100, v100, v100
    v_lshlrev_b32 v100, 16, v100
    v_mul_f32 v103, v100, v101
    v_mfma_f32_32x32x16_bf16 v[48:63], v[164:167], v[168:171], v[48:63]
    v_mul_f32 v103, s96, v103
    v_mul_f32 v104, v100, v102
    v_mul_f32 v104, 0.15915494, v104
    v_exp_f32 v111, v103
    v_mfma_f32_32x32x16_bf16 v[64:79], v[164:167], v[172:175], v[64:79]
    v_rndne_f32 v113, v104
    v_sub_f32 v112, v104, v113
    v_cos_f32 v16, v112
    v_sin_f32 v17, v112
    s_waitcnt lgkmcnt(0)
    s_barrier
    v_mfma_f32_32x32x16_bf16 v[48:63], v[176:179], v[180:183], v[48:63]
    ds_read_b128 v[128:131], v12 offset:0
    ds_read_b128 v[132:135], v6 offset:16384
    ds_read_b128 v[136:139], v6 offset:20480
    v_mfma_f32_32x32x16_bf16 v[64:79], v[176:179], v[184:187], v[64:79]
    ds_read_b128 v[140:143], v13 offset:0
    ds_read_b128 v[144:147], v7 offset:16384
    ds_read_b128 v[148:151], v7 offset:20480
    v_mfma_f32_32x32x16_bf16 v[48:63], v[188:191], v[192:195], v[48:63]
    ds_read_b128 v[152:155], v14 offset:0
    ds_read_b128 v[156:159], v8 offset:16384
    ds_read_b128 v[160:163], v8 offset:20480
    v_mfma_f32_32x32x16_bf16 v[64:79], v[188:191], v[196:199], v[64:79]
    ds_read_b128 v[164:167], v15 offset:0
    ds_read_b128 v[168:171], v9 offset:16384
    ds_read_b128 v[172:175], v9 offset:20480
    v_mfma_f32_32x32x16_bf16 v[48:63], v[200:203], v[204:207], v[48:63]
    v_mul_f32 v16, v111, v16
    v_mul_f32 v17, v111, v17
    v_mul_f32 v111, 0x41800000, v103
    v_mul_f32 v112, 0x41800000, v104
    v_mfma_f32_32x32x16_bf16 v[64:79], v[200:203], v[208:211], v[64:79]
    v_exp_f32 v111, v111
    v_rndne_f32 v113, v112
    v_sub_f32 v112, v112, v113
    v_cos_f32 v18, v112
    v_mfma_f32_32x32x16_bf16 v[48:63], v[212:215], v[216:219], v[48:63]
    v_sin_f32 v19, v112
    v_mul_f32 v18, v111, v18
    v_mul_f32 v19, v111, v19
    v_mul_f32 v111, v106, v103
    v_mfma_f32_32x32x16_bf16 v[64:79], v[212:215], v[220:223], v[64:79]
    v_mul_f32 v112, v106, v104
    v_exp_f32 v111, v111
    v_rndne_f32 v113, v112
    v_sub_f32 v112, v112, v113
    s_waitcnt lgkmcnt(0)
    s_barrier
    v_mfma_f32_32x32x16_bf16 v[48:63], v[128:131], v[132:135], v[48:63]
    ds_read_b128 v[176:179], v12 offset:16384
    ds_read_b128 v[180:183], v6 offset:0
    ds_read_b128 v[184:187], v6 offset:4096
    v_mfma_f32_32x32x16_bf16 v[64:79], v[128:131], v[136:139], v[64:79]
    ds_read_b128 v[188:191], v13 offset:16384
    ds_read_b128 v[192:195], v7 offset:0
    ds_read_b128 v[196:199], v7 offset:4096
    v_mfma_f32_32x32x16_bf16 v[48:63], v[140:143], v[144:147], v[48:63]
    ds_read_b128 v[200:203], v14 offset:16384
    ds_read_b128 v[204:207], v8 offset:0
    ds_read_b128 v[208:211], v8 offset:4096
    v_mfma_f32_32x32x16_bf16 v[64:79], v[140:143], v[148:151], v[64:79]
    ds_read_b128 v[212:215], v15 offset:16384
    ds_read_b128 v[216:219], v9 offset:0
    ds_read_b128 v[220:223], v9 offset:4096
    v_mfma_f32_32x32x16_bf16 v[48:63], v[152:155], v[156:159], v[48:63]
    v_cos_f32 v20, v112
    v_sin_f32 v21, v112
    v_mul_f32 v20, v111, v20
    v_mul_f32 v21, v111, v21
    v_mfma_f32_32x32x16_bf16 v[64:79], v[152:155], v[160:163], v[64:79]
    v_mul_f32 v111, v107, v103
    v_mul_f32 v112, v107, v104
    v_exp_f32 v111, v111
    v_rndne_f32 v113, v112
    v_mfma_f32_32x32x16_bf16 v[48:63], v[164:167], v[168:171], v[48:63]
    v_sub_f32 v112, v112, v113
    v_cos_f32 v22, v112
    v_sin_f32 v23, v112
    v_mul_f32 v22, v111, v22
    v_mfma_f32_32x32x16_bf16 v[64:79], v[164:167], v[172:175], v[64:79]
    v_mul_f32 v23, v111, v23
    v_mul_f32 v111, v108, v103
    v_mul_f32 v112, v108, v104
    v_exp_f32 v111, v111
    s_waitcnt lgkmcnt(0)
    s_barrier
    v_mfma_f32_32x32x16_bf16 v[48:63], v[176:179], v[180:183], v[48:63]
    ds_read_b128 v[128:131], v12 offset:32768
    ds_read_b128 v[132:135], v6 offset:8192
    ds_read_b128 v[136:139], v6 offset:12288
    v_mfma_f32_32x32x16_bf16 v[64:79], v[176:179], v[184:187], v[64:79]
    ds_read_b128 v[140:143], v13 offset:32768
    ds_read_b128 v[144:147], v7 offset:8192
    ds_read_b128 v[148:151], v7 offset:12288
    v_mfma_f32_32x32x16_bf16 v[48:63], v[188:191], v[192:195], v[48:63]
    ds_read_b128 v[152:155], v14 offset:32768
    ds_read_b128 v[156:159], v8 offset:8192
    ds_read_b128 v[160:163], v8 offset:12288
    v_mfma_f32_32x32x16_bf16 v[64:79], v[188:191], v[196:199], v[64:79]
    ds_read_b128 v[164:167], v15 offset:32768
    ds_read_b128 v[168:171], v9 offset:8192
    ds_read_b128 v[172:175], v9 offset:12288
    v_mfma_f32_32x32x16_bf16 v[48:63], v[200:203], v[204:207], v[48:63]
    v_rndne_f32 v113, v112
    v_sub_f32 v112, v112, v113
    v_cos_f32 v24, v112
    v_sin_f32 v25, v112
    v_mfma_f32_32x32x16_bf16 v[64:79], v[200:203], v[208:211], v[64:79]
    v_mul_f32 v24, v111, v24
    v_mul_f32 v25, v111, v25
    v_add_f32 v111, -1.0, v16
    v_mul_f32 v112, v101, v101
    v_mfma_f32_32x32x16_bf16 v[48:63], v[212:215], v[216:219], v[48:63]
    v_fmac_f32 v112, v102, v102
    v_rcp_f32 v112, v112
    v_mul_f32 v26, v111, v101
    v_fmac_f32 v26, v17, v102
    v_mfma_f32_32x32x16_bf16 v[64:79], v[212:215], v[220:223], v[64:79]
    v_mul_f32 v27, v17, v101
    v_fma_f32 v27, -v111, v102, v27
    v_add_f32 v112, v112, v112
    v_mul_f32 v26, v26, v112
    s_waitcnt lgkmcnt(0)
    s_barrier
    v_mfma_f32_32x32x16_bf16 v[48:63], v[128:131], v[132:135], v[48:63]
    ds_read_b128 v[176:179], v12 offset:49152
    ds_read_b128 v[180:183], v6 offset:16384
    ds_read_b128 v[184:187], v6 offset:20480
    v_mfma_f32_32x32x16_bf16 v[64:79], v[128:131], v[136:139], v[64:79]
    ds_read_b128 v[188:191], v13 offset:49152
    ds_read_b128 v[192:195], v7 offset:16384
    ds_read_b128 v[196:199], v7 offset:20480
    v_mfma_f32_32x32x16_bf16 v[48:63], v[140:143], v[144:147], v[48:63]
    ds_read_b128 v[200:203], v14 offset:49152
    ds_read_b128 v[204:207], v8 offset:16384
    ds_read_b128 v[208:211], v8 offset:20480
    v_mfma_f32_32x32x16_bf16 v[64:79], v[140:143], v[148:151], v[64:79]
    ds_read_b128 v[212:215], v15 offset:49152
    ds_read_b128 v[216:219], v9 offset:16384
    ds_read_b128 v[220:223], v9 offset:20480
    v_mfma_f32_32x32x16_bf16 v[48:63], v[152:155], v[156:159], v[48:63]
    v_mul_f32 v27, v27, v112
    v_mov_b32 v114, s86
    v_mov_b32 v115, s87
    v_lshlrev_b32 v116, 1, v35
    v_mfma_f32_32x32x16_bf16 v[64:79], v[152:155], v[160:163], v[64:79]
    v_mfma_f32_32x32x16_bf16 v[48:63], v[164:167], v[168:171], v[48:63]
    v_mfma_f32_32x32x16_bf16 v[64:79], v[164:167], v[172:175], v[64:79]
    s_waitcnt lgkmcnt(0)
    s_barrier
    v_mfma_f32_32x32x16_bf16 v[48:63], v[176:179], v[180:183], v[48:63]
    ds_read_b128 v[128:131], v12 offset:0
    ds_read_b128 v[132:135], v6 offset:0
    ds_read_b128 v[136:139], v6 offset:4096
    v_mfma_f32_32x32x16_bf16 v[64:79], v[176:179], v[184:187], v[64:79]
    ds_read_b128 v[140:143], v13 offset:0
    ds_read_b128 v[144:147], v7 offset:0
    ds_read_b128 v[148:151], v7 offset:4096
    v_mfma_f32_32x32x16_bf16 v[48:63], v[188:191], v[192:195], v[48:63]
    ds_read_b128 v[152:155], v14 offset:0
    ds_read_b128 v[156:159], v8 offset:0
    ds_read_b128 v[160:163], v8 offset:4096
    v_mfma_f32_32x32x16_bf16 v[64:79], v[188:191], v[196:199], v[64:79]
    ds_read_b128 v[164:167], v15 offset:0
    ds_read_b128 v[168:171], v9 offset:0
    ds_read_b128 v[172:175], v9 offset:4096
    v_mfma_f32_32x32x16_bf16 v[48:63], v[200:203], v[204:207], v[48:63]
    v_mfma_f32_32x32x16_bf16 v[64:79], v[200:203], v[208:211], v[64:79]
    v_mfma_f32_32x32x16_bf16 v[48:63], v[212:215], v[216:219], v[48:63]
    v_mfma_f32_32x32x16_bf16 v[64:79], v[212:215], v[220:223], v[64:79]
    s_waitcnt lgkmcnt(0)
    s_barrier
    v_mfma_f32_32x32x16_bf16 v[48:63], v[128:131], v[132:135], v[48:63]
    ds_read_b128 v[176:179], v12 offset:16384
    ds_read_b128 v[180:183], v6 offset:8192
    ds_read_b128 v[184:187], v6 offset:12288
    v_mfma_f32_32x32x16_bf16 v[64:79], v[128:131], v[136:139], v[64:79]
    ds_read_b128 v[188:191], v13 offset:16384
    ds_read_b128 v[192:195], v7 offset:8192
    ds_read_b128 v[196:199], v7 offset:12288
    v_mfma_f32_32x32x16_bf16 v[48:63], v[140:143], v[144:147], v[48:63]
    ds_read_b128 v[200:203], v14 offset:16384
    ds_read_b128 v[204:207], v8 offset:8192
    ds_read_b128 v[208:211], v8 offset:12288
    v_mfma_f32_32x32x16_bf16 v[64:79], v[140:143], v[148:151], v[64:79]
    ds_read_b128 v[212:215], v15 offset:16384
    ds_read_b128 v[216:219], v9 offset:8192
    ds_read_b128 v[220:223], v9 offset:12288
    v_mfma_f32_32x32x16_bf16 v[48:63], v[152:155], v[156:159], v[48:63]
    v_mfma_f32_32x32x16_bf16 v[64:79], v[152:155], v[160:163], v[64:79]
    v_mfma_f32_32x32x16_bf16 v[48:63], v[164:167], v[168:171], v[48:63]
    v_mfma_f32_32x32x16_bf16 v[64:79], v[164:167], v[172:175], v[64:79]
    s_cmp_eq_u32 s90, 3
    s_cbranch_scc1 L_tc20
    s_lshl_b32 s94, s2, 11
    v_lshl_add_u32 v10, v0, 7, s94
    s_cmp_eq_u32 s90, 1
    s_cselect_b64 s[70:71], s[48:49], s[46:47]
    s_cmp_eq_u32 s90, 2
    s_cselect_b64 s[70:71], s[60:61], s[70:71]
    s_mov_b64 exec, 0xffff
    global_load_dword v10, v10, s[70:71]
    s_mov_b64 exec, -1
L_tc20:
    s_setprio 2
    s_waitcnt lgkmcnt(9)
    v_mfma_f32_32x32x16_bf16 v[48:63], v[176:179], v[180:183], v[48:63]
    v_mfma_f32_32x32x16_bf16 v[64:79], v[176:179], v[184:187], v[64:79]
    s_waitcnt lgkmcnt(6)
    v_mfma_f32_32x32x16_bf16 v[48:63], v[188:191], v[192:195], v[48:63]
    v_mfma_f32_32x32x16_bf16 v[64:79], v[188:191], v[196:199], v[64:79]
    s_waitcnt lgkmcnt(3)
    v_mfma_f32_32x32x16_bf16 v[48:63], v[200:203], v[204:207], v[48:63]
    v_mfma_f32_32x32x16_bf16 v[64:79], v[200:203], v[208:211], v[64:79]
    s_waitcnt lgkmcnt(0)
    v_mfma_f32_32x32x16_bf16 v[48:63], v[212:215], v[216:219], v[48:63]
    v_mfma_f32_32x32x16_bf16 v[64:79], v[212:215], v[220:223], v[64:79]
    s_sub_u32 s94, s93, 139264
    v_add_u32 v6, s94, v6
    v_add_u32 v7, s94, v7
    v_add_u32 v8, s94, v8
    v_add_u32 v9, s94, v9
    s_cmp_lg_u32 s90, 3
    s_cbranch_scc1 L_s8
    s_mov_b64 exec, 1
    buffer_store_dword v114, off, s[28:31], s16 sc1
    s_mov_b64 exec, -1
L_s8:
    s_nop 0
    v_fma_f32 v30, v16, v48, v49
    v_fma_f32 v31, v16, v64, v65
    v_fma_f32 v30, -v17, v64, v30
    v_fma_f32 v31, v17, v48, v31
    v_fma_f32 v96, v16, v30, v50
    v_fma_f32 v97, v16, v31, v66
    v_fma_f32 v96, -v17, v31, v96
    v_fma_f32 v97, v17, v30, v97
    v_fma_f32 v30, v16, v96, v51
    v_fma_f32 v31, v16, v97, v67
    v_fma_f32 v30, -v17, v97, v30
    v_fma_f32 v31, v17, v96, v31
    v_fma_f32 v96, v16, v30, v52
    v_fma_f32 v97, v16, v31, v68
    v_fma_f32 v96, -v17, v31, v96
    v_fma_f32 v97, v17, v30, v97
    v_fma_f32 v30, v16, v96, v53
    v_fma_f32 v31, v16, v97, v69
    v_fma_f32 v30, -v17, v97, v30
    v_fma_f32 v31, v17, v96, v31
    v_fma_f32 v96, v16, v30, v54
    v_fma_f32 v97, v16, v31, v70
    v_fma_f32 v96, -v17, v31, v96
    v_fma_f32 v97, v17, v30, v97
    v_fma_f32 v30, v16, v96, v55
    v_fma_f32 v31, v16, v97, v71
    v_fma_f32 v30, -v17, v97, v30
    v_fma_f32 v31, v17, v96, v31
    v_fma_f32 v96, v16, v30, v56
    v_fma_f32 v97, v16, v31, v72
    v_fma_f32 v96, -v17, v31, v96
    v_fma_f32 v97, v17, v30, v97
    v_fma_f32 v30, v16, v96, v57
    v_fma_f32 v31, v16, v97, v73
    v_fma_f32 v30, -v17, v97, v30
    v_fma_f32 v31, v17, v96, v31
    v_fma_f32 v96, v16, v30, v58
    v_fma_f32 v97, v16, v31, v74
    v_fma_f32 v96, -v17, v31, v96
    v_fma_f32 v97, v17, v30, v97
    v_fma_f32 v30, v16, v96, v59
    v_fma_f32 v31, v16, v97, v75
    v_fma_f32 v30, -v17, v97, v30
    v_fma_f32 v31, v17, v96, v31
    v_fma_f32 v96, v16, v30, v60
    v_fma_f32 v97, v16, v31, v76
    v_fma_f32 v96, -v17, v31, v96
    v_fma_f32 v97, v17, v30, v97
    v_fma_f32 v30, v16, v96, v61
    v_fma_f32 v31, v16, v97, v77
    v_fma_f32 v30, -v17, v97, v30
    v_fma_f32 v31, v17, v96, v31
    v_fma_f32 v96, v16, v30, v62
    v_fma_f32 v97, v16, v31, v78
    v_fma_f32 v96, -v17, v31, v96
    v_fma_f32 v97, v17, v30, v97
    v_fma_f32 v30, v16, v96, v63
    v_fma_f32 v31, v16, v97, v79
    v_fma_f32 v30, -v17, v97, v30
    v_fma_f32 v31, v17, v96, v31
    ds_write_b64 v34, v[30:31] offset:2048
    s_waitcnt lgkmcnt(0)
    s_barrier
    ds_read_b64 v[96:97], v34 offset:256
    ds_read_b64 v[98:99], v34 offset:512
    ds_read_b64 v[100:101], v34 offset:768
    ds_read_b64 v[102:103], v34 offset:1024
    ds_read_b64 v[104:105], v34 offset:1280
    ds_read_b64 v[106:107], v34 offset:1536
    ds_read_b64 v[108:109], v34 offset:1792
    s_waitcnt lgkmcnt(5)
    v_fma_f32 v98, v18, v96, v98
    v_fma_f32 v99, v18, v97, v99
    v_fma_f32 v98, -v19, v97, v98
    v_fma_f32 v99, v19, v96, v99
    s_waitcnt lgkmcnt(4)
    v_fma_f32 v100, v18, v98, v100
    v_fma_f32 v101, v18, v99, v101
    v_fma_f32 v100, -v19, v99, v100
    v_fma_f32 v101, v19, v98, v101
    s_waitcnt lgkmcnt(3)
    v_fma_f32 v102, v18, v100, v102
    v_fma_f32 v103, v18, v101, v103
    v_fma_f32 v102, -v19, v101, v102
    v_fma_f32 v103, v19, v100, v103
    s_waitcnt lgkmcnt(2)
    v_fma_f32 v104, v18, v102, v104
    v_fma_f32 v105, v18, v103, v105
    v_fma_f32 v104, -v19, v103, v104
    v_fma_f32 v105, v19, v102, v105
    s_waitcnt lgkmcnt(1)
    v_fma_f32 v106, v18, v104, v106
    v_fma_f32 v107, v18, v105, v107
    v_fma_f32 v106, -v19, v105, v106
    v_fma_f32 v107, v19, v104, v107
    s_waitcnt lgkmcnt(0)
    v_fma_f32 v28, v18, v106, v108
    v_fma_f32 v29, v18, v107, v109
    v_fma_f32 v28, -v19, v107, v28
    v_fma_f32 v29, v19, v106, v29
    v_fma_f32 v112, v18, v28, v30
    v_fma_f32 v113, v18, v29, v31
    v_fma_f32 v112, -v19, v29, v112
    v_fma_f32 v113, v19, v28, v113
    s_cmp_lg_u32 s90, 3
    s_cbranch_scc1 L_s4
    s_mov_b32 exec_lo, 0
    buffer_store_dwordx4 v[112:115], v116, s[28:31], s82 offen sc1
    s_mov_b64 exec, -1
L_s4:
    v_mov_b32 v104, 0
    s_mov_b64 exec, 15
    buffer_atomic_add v104, v5, s[28:31], s17 offen sc0 sc1
    s_mov_b64 exec, -1
    s_setprio 0
    v_mul_f32 v80, v26, v48
    v_fma_f32 v80, -v27, v64, v80
    v_mul_f32 v64, -v26, v64
    v_fma_f32 v64, -v27, v48, v64
    v_mul_f32 v81, v26, v49
    v_fma_f32 v81, -v27, v65, v81
    v_mul_f32 v65, -v26, v65
    v_fma_f32 v65, -v27, v49, v65
    v_mul_f32 v82, v26, v50
    v_fma_f32 v82, -v27, v66, v82
    v_mul_f32 v66, -v26, v66
    v_fma_f32 v66, -v27, v50, v66
    v_mul_f32 v83, v26, v51
    v_fma_f32 v83, -v27, v67, v83
    v_mul_f32 v67, -v26, v67
    v_fma_f32 v67, -v27, v51, v67
    v_mul_f32 v84, v26, v52
    v_fma_f32 v84, -v27, v68, v84
    v_mul_f32 v68, -v26, v68
    v_fma_f32 v68, -v27, v52, v68
    v_mul_f32 v85, v26, v53
    v_fma_f32 v85, -v27, v69, v85
    v_mul_f32 v69, -v26, v69
    v_fma_f32 v69, -v27, v53, v69
    v_mul_f32 v86, v26, v54
    v_fma_f32 v86, -v27, v70, v86
    v_mul_f32 v70, -v26, v70
    v_fma_f32 v70, -v27, v54, v70
    v_mul_f32 v87, v26, v55
    v_fma_f32 v87, -v27, v71, v87
    v_mul_f32 v71, -v26, v71
    v_fma_f32 v71, -v27, v55, v71
    v_mul_f32 v88, v26, v56
    v_fma_f32 v88, -v27, v72, v88
    v_mul_f32 v72, -v26, v72
    v_fma_f32 v72, -v27, v56, v72
    v_mul_f32 v89, v26, v57
    v_fma_f32 v89, -v27, v73, v89
    v_mul_f32 v73, -v26, v73
    v_fma_f32 v73, -v27, v57, v73
    v_mul_f32 v90, v26, v58
    v_fma_f32 v90, -v27, v74, v90
    v_mul_f32 v74, -v26, v74
    v_fma_f32 v74, -v27, v58, v74
    v_mul_f32 v91, v26, v59
    v_fma_f32 v91, -v27, v75, v91
    v_mul_f32 v75, -v26, v75
    v_fma_f32 v75, -v27, v59, v75
    v_mul_f32 v92, v26, v60
    v_fma_f32 v92, -v27, v76, v92
    v_mul_f32 v76, -v26, v76
    v_fma_f32 v76, -v27, v60, v76
    v_mul_f32 v93, v26, v61
    v_fma_f32 v93, -v27, v77, v93
    v_mul_f32 v77, -v26, v77
    v_fma_f32 v77, -v27, v61, v77
    v_mul_f32 v94, v26, v62
    v_fma_f32 v94, -v27, v78, v94
    v_mul_f32 v78, -v26, v78
    v_fma_f32 v78, -v27, v62, v78
    v_mul_f32 v95, v26, v63
    v_fma_f32 v95, -v27, v79, v95
    v_mul_f32 v79, -v26, v79
    v_fma_f32 v79, -v27, v63, v79
    s_waitcnt vmcnt(0)
    v_cmp_ne_u32 vcc, s86, v104
    s_nop 0
    s_and_b64 vcc, vcc, s[18:19]
    s_cbranch_scc0 L_pd24
    s_mov_b32 s94, 20000
L_pl23:
    s_sleep 2
    v_mov_b32 v104, 0
    s_mov_b64 exec, s[18:19]
    buffer_atomic_add v104, v5, s[28:31], s17 offen sc0 sc1
    s_mov_b64 exec, -1
    s_sub_u32 s94, s94, 1
    s_waitcnt vmcnt(0)
    s_cbranch_scc1 L_pd24
    v_cmp_ne_u32 vcc, s86, v104
    s_nop 0
    s_and_b64 vcc, vcc, s[18:19]
    s_cbranch_scc1 L_pl23
    s_sleep 8
L_pd24:
    buffer_load_dwordx4 v[96:99], v32, s[28:31], 0 offen sc1
    buffer_load_dwordx4 v[100:103], v33, s[28:31], 0 offen sc1
    s_add_u32 m0, s93, 0
    s_mov_b32 s55, 0
    buffer_load_dwordx4 v36, s[8:11], s55 offen offset:0 lds
    buffer_load_dwordx4 v37, s[8:11], s55 offen offset:1024 lds
    buffer_load_dwordx4 v38, s[8:11], s55 offen offset:2048 lds
    buffer_load_dwordx4 v39, s[8:11], s55 offen offset:3072 lds
    s_add_u32 m0, s93, 4096
    s_mov_b32 s55, 32768
    buffer_load_dwordx4 v36, s[8:11], s55 offen offset:0 lds
    buffer_load_dwordx4 v37, s[8:11], s55 offen offset:1024 lds
    buffer_load_dwordx4 v38, s[8:11], s55 offen offset:2048 lds
    buffer_load_dwordx4 v39, s[8:11], s55 offen offset:3072 lds
    s_lshl_b32 s94, s88, 1
    s_lshr_b32 s95, s90, 1
    s_add_u32 s94, s94, s95
    s_lshl_b32 s94, s94, 2
    s_lshr_b32 s95, s89, 2
    s_add_u32 s94, s94, s95
    s_lshl_b32 s94, s94, 7
    s_and_b32 s95, s89, 3
    s_lshl_b32 s95, s95, 4
    s_add_u32 s94, s94, s95
    s_and_b32 s95, s90, 1
    s_lshl_b32 s95, s95, 3
    s_add_u32 s94, s94, s95
    s_add_u32 s16, s94, 20480
    s_mov_b32 s94, 20000
    s_waitcnt vmcnt(8)
    v_cmp_ne_u64 vcc, s[86:87], v[98:99]
    v_cmp_ne_u64 s[98:99], s[86:87], v[102:103]
    s_and_b64 vcc, vcc, s[78:79]
    s_and_b64 s[98:99], s[98:99], s[80:81]
    s_or_b64 vcc, vcc, s[98:99]
    s_cbranch_scc0 L_ed22
L_ep21:
    buffer_load_dwordx4 v[96:99], v32, s[28:31], 0 offen sc1
    buffer_load_dwordx4 v[100:103], v33, s[28:31], 0 offen sc1
    s_sub_u32 s94, s94, 1
    s_waitcnt vmcnt(0)
    s_cbranch_scc1 L_ed22
    v_cmp_ne_u64 vcc, s[86:87], v[98:99]
    v_cmp_ne_u64 s[98:99], s[86:87], v[102:103]
    s_and_b64 vcc, vcc, s[78:79]
    s_and_b64 s[98:99], s[98:99], s[80:81]
    s_or_b64 vcc, vcc, s[98:99]
    s_cbranch_scc0 L_ed22
    s_sleep 2
    s_branch L_ep21
L_ed22:
    v_mul_f32 v104, v22, v96
    v_mul_f32 v105, v22, v97
    v_fma_f32 v104, -v23, v97, v104
    v_fma_f32 v105, v23, v96, v105
    v_fma_f32 v104, v24, v100, v104
    v_fma_f32 v105, v24, v101, v105
    v_fma_f32 v104, -v25, v101, v104
    v_fma_f32 v105, v25, v100, v105
    ds_write_b64 v34, v[104:105] offset:24576
    v_add_u32 v35, 158720, v35
    v_mov_b32 v96, 1
    s_mov_b64 exec, 1
    ds_write_b32 v1, v96
    s_mov_b64 exec, -1
L_rs25:
    ds_read_b128 v[96:99], v2
    s_waitcnt lgkmcnt(0)
    v_min3_u32 v96, v96, v97, v98
    v_min_u32 v96, v96, v99
    v_cmp_gt_u32 vcc, 1, v96
    s_cbranch_vccnz L_rs25
    s_add_u32 m0, s93, 8192
    s_mov_b32 s55, 0
    buffer_load_dwordx4 v36, s[12:15], s55 offen offset:0 lds
    buffer_load_dwordx4 v37, s[12:15], s55 offen offset:1024 lds
    buffer_load_dwordx4 v38, s[12:15], s55 offen offset:2048 lds
    buffer_load_dwordx4 v39, s[12:15], s55 offen offset:3072 lds
    s_add_u32 m0, s93, 12288
    s_mov_b32 s55, 32768
    buffer_load_dwordx4 v36, s[12:15], s55 offen offset:0 lds
    buffer_load_dwordx4 v37, s[12:15], s55 offen offset:1024 lds
    buffer_load_dwordx4 v38, s[12:15], s55 offen offset:2048 lds
    buffer_load_dwordx4 v39, s[12:15], s55 offen offset:3072 lds
    s_setprio 1
    ds_read_b64 v[96:97], v35 offset:0
    ds_read_b64 v[98:99], v35 offset:256
    ds_read_b64 v[100:101], v35 offset:512
    ds_read_b64 v[102:103], v35 offset:768
    ds_read_b64 v[104:105], v35 offset:1024
    ds_read_b64 v[106:107], v35 offset:1280
    ds_read_b64 v[108:109], v35 offset:1536
    ds_read_b64 v[110:111], v35 offset:1792
    s_waitcnt lgkmcnt(6)
    v_add_f32 v96, v96, v98
    v_add_f32 v97, v97, v99
    s_waitcnt lgkmcnt(5)
    v_add_f32 v96, v96, v100
    v_add_f32 v97, v97, v101
    s_waitcnt lgkmcnt(4)
    v_add_f32 v96, v96, v102
    v_add_f32 v97, v97, v103
    s_waitcnt lgkmcnt(3)
    v_add_f32 v96, v96, v104
    v_add_f32 v97, v97, v105
    s_waitcnt lgkmcnt(2)
    v_add_f32 v96, v96, v106
    v_add_f32 v97, v97, v107
    s_waitcnt lgkmcnt(1)
    v_add_f32 v96, v96, v108
    v_add_f32 v97, v97, v109
    s_waitcnt lgkmcnt(0)
    v_add_f32 v96, v96, v110
    v_add_f32 v97, v97, v111
    v_fma_f32 v28, v20, v96, v28
    v_fma_f32 v29, v20, v97, v29
    v_fma_f32 v28, -v21, v97, v28
    v_fma_f32 v29, v21, v96, v29
    v_mul_f32 v30, v26, v28
    v_fma_f32 v30, -v27, v29, v30
    v_mul_f32 v31, -v26, v29
    v_fma_f32 v31, -v27, v28, v31
    v_fmac_f32 v80, v16, v30
    v_fmac_f32 v64, v16, v31
    v_fmac_f32 v80, v17, v31
    v_fma_f32 v64, -v17, v30, v64
    v_fmac_f32 v81, v16, v80
    v_fmac_f32 v65, v16, v64
    v_fmac_f32 v81, v17, v64
    v_fma_f32 v65, -v17, v80, v65
    v_fmac_f32 v82, v16, v81
    v_fmac_f32 v66, v16, v65
    v_fmac_f32 v82, v17, v65
    v_fma_f32 v66, -v17, v81, v66
    v_fmac_f32 v83, v16, v82
    v_fmac_f32 v67, v16, v66
    v_fmac_f32 v83, v17, v66
    v_fma_f32 v67, -v17, v82, v67
    v_fmac_f32 v84, v16, v83
    v_fmac_f32 v68, v16, v67
    v_fmac_f32 v84, v17, v67
    v_fma_f32 v68, -v17, v83, v68
    v_fmac_f32 v85, v16, v84
    v_fmac_f32 v69, v16, v68
    v_fmac_f32 v85, v17, v68
    v_fma_f32 v69, -v17, v84, v69
    v_fmac_f32 v86, v16, v85
    v_fmac_f32 v70, v16, v69
    v_fmac_f32 v86, v17, v69
    v_fma_f32 v70, -v17, v85, v70
    v_fmac_f32 v87, v16, v86
    v_fmac_f32 v71, v16, v70
    v_fmac_f32 v87, v17, v70
    v_fma_f32 v71, -v17, v86, v71
    v_fmac_f32 v88, v16, v87
    v_fmac_f32 v72, v16, v71
    v_fmac_f32 v88, v17, v71
    v_fma_f32 v72, -v17, v87, v72
    v_cvt_pk_bf16_f32 v96, v80, v81
    v_cvt_pk_bf16_f32 v97, v82, v83
    v_cvt_pk_bf16_f32 v98, v84, v85
    v_cvt_pk_bf16_f32 v99, v86, v87
    v_cvt_pk_bf16_f32 v104, v64, v65
    v_cvt_pk_bf16_f32 v105, v66, v67
    v_cvt_pk_bf16_f32 v106, v68, v69
    v_cvt_pk_bf16_f32 v107, v70, v71
    v_mfma_f32_32x32x16_bf16 v[48:63], v[96:99], v[40:43], 0
    s_nop 0
    v_mfma_f32_32x32x16_bf16 v[112:127], v[104:107], v[40:43], 0
    v_fmac_f32 v89, v16, v88
    v_fmac_f32 v73, v16, v72
    v_fmac_f32 v89, v17, v72
    v_fma_f32 v73, -v17, v88, v73
    v_fmac_f32 v90, v16, v89
    v_fmac_f32 v74, v16, v73
    v_fmac_f32 v90, v17, v73
    v_fma_f32 v74, -v17, v89, v74
    v_fmac_f32 v91, v16, v90
    v_fmac_f32 v75, v16, v74
    v_fmac_f32 v91, v17, v74
    v_fma_f32 v75, -v17, v90, v75
    v_fmac_f32 v92, v16, v91
    v_fmac_f32 v76, v16, v75
    v_fmac_f32 v92, v17, v75
    v_fma_f32 v76, -v17, v91, v76
    v_fmac_f32 v93, v16, v92
    v_fmac_f32 v77, v16, v76
    v_fmac_f32 v93, v17, v76
    v_fma_f32 v77, -v17, v92, v77
    v_fmac_f32 v94, v16, v93
    v_fmac_f32 v78, v16, v77
    v_fmac_f32 v94, v17, v77
    v_fma_f32 v78, -v17, v93, v78
    v_fmac_f32 v95, v16, v94
    v_fmac_f32 v79, v16, v78
    v_fmac_f32 v95, v17, v78
    v_fma_f32 v79, -v17, v94, v79
    v_cvt_pk_bf16_f32 v100, v88, v89
    v_cvt_pk_bf16_f32 v101, v90, v91
    v_cvt_pk_bf16_f32 v102, v92, v93
    v_cvt_pk_bf16_f32 v103, v94, v95
    s_nop 1
    v_mfma_f32_32x32x16_bf16 v[48:63], v[100:103], v[44:47], v[48:63]
    v_cvt_pk_bf16_f32 v108, v72, v73
    v_cvt_pk_bf16_f32 v109, v74, v75
    v_cvt_pk_bf16_f32 v110, v76, v77
    v_cvt_pk_bf16_f32 v111, v78, v79
    s_nop 1
    v_mfma_f32_32x32x16_bf16 v[112:127], v[108:111], v[44:47], v[112:127]
    s_nop 4
    v_cvt_pk_bf16_f32 v64, v48, v49
    v_cvt_pk_bf16_f32 v65, v50, v51
    v_cvt_pk_bf16_f32 v66, v52, v53
    v_cvt_pk_bf16_f32 v67, v54, v55
    buffer_store_dwordx4 v[64:67], v3, s[28:31], s83 offen offset:0 sc1
    v_cvt_pk_bf16_f32 v68, v56, v57
    v_cvt_pk_bf16_f32 v69, v58, v59
    v_cvt_pk_bf16_f32 v70, v60, v61
    v_cvt_pk_bf16_f32 v71, v62, v63
    buffer_store_dwordx4 v[68:71], v3, s[28:31], s83 offen offset:1024 sc1
    v_cvt_pk_bf16_f32 v72, v112, v113
    v_cvt_pk_bf16_f32 v73, v114, v115
    v_cvt_pk_bf16_f32 v74, v116, v117
    v_cvt_pk_bf16_f32 v75, v118, v119
    buffer_store_dwordx4 v[72:75], v3, s[28:31], s83 offen offset:2304 sc1
    v_cvt_pk_bf16_f32 v76, v120, v121
    v_cvt_pk_bf16_f32 v77, v122, v123
    v_cvt_pk_bf16_f32 v78, v124, v125
    v_cvt_pk_bf16_f32 v79, v126, v127
    buffer_store_dwordx4 v[76:79], v3, s[28:31], s83 offen offset:3328 sc1
    s_setprio 0
    s_waitcnt vmcnt(12)
    s_waitcnt lgkmcnt(7)
    ds_read_b128 v[128:131], v6 offset:0
    ds_read_b128 v[132:135], v6 offset:4096
    ds_read_b128 v[136:139], v7 offset:0
    ds_read_b128 v[140:143], v7 offset:4096
    ds_read_b128 v[160:163], v8 offset:0
    ds_read_b128 v[164:167], v8 offset:4096
    ds_read_b128 v[168:171], v9 offset:0
    ds_read_b128 v[172:175], v9 offset:4096
    s_waitcnt lgkmcnt(0)
    s_add_u32 m0, s93, 0
    s_mov_b32 s55, 128
    buffer_load_dwordx4 v36, s[8:11], s55 offen offset:0 lds
    buffer_load_dwordx4 v37, s[8:11], s55 offen offset:1024 lds
    buffer_load_dwordx4 v38, s[8:11], s55 offen offset:2048 lds
    buffer_load_dwordx4 v39, s[8:11], s55 offen offset:3072 lds
    s_add_u32 m0, s93, 4096
    s_mov_b32 s55, 32896
    buffer_load_dwordx4 v36, s[8:11], s55 offen offset:0 lds
    buffer_load_dwordx4 v37, s[8:11], s55 offen offset:1024 lds
    buffer_load_dwordx4 v38, s[8:11], s55 offen offset:2048 lds
    buffer_load_dwordx4 v39, s[8:11], s55 offen offset:3072 lds
    s_lshr_b32 s94, s89, 3
    s_lshl_b32 s95, s88, 1
    s_add_u32 s94, s94, s95
    s_lshl_b32 s17, s94, 2
    s_add_u32 s17, s17, s90
    s_lshl_b32 s17, s17, 7
    s_add_u32 s17, s17, 20480
    s_lshl_b32 s70, s94, 3
    s_add_u32 s70, s70, s90
    s_mul_i32 s70, s70, 18432
    s_add_u32 s70, s70, 2097152
    v_lshlrev_b32 v18, 3, v0
    s_add_u32 s71, s70, 73728
    s_add_u32 s72, s70, 4608
    s_add_u32 s73, s70, 78336
    s_add_u32 s74, s70, 9216
    s_add_u32 s75, s70, 82944
    s_add_u32 s76, s70, 13824
    s_add_u32 s77, s70, 87552
    s_waitcnt vmcnt(8)
    v_mov_b32 v16, s86
    v_mov_b32 v17, s87
    s_mov_b64 exec, 1
    buffer_store_dwordx2 v[16:17], off, s[28:31], s16 sc1
    s_mov_b64 exec, -1
    s_waitcnt lgkmcnt(7)
    ds_read_b128 v[144:147], v6 offset:8192
    ds_read_b128 v[148:151], v6 offset:12288
    ds_read_b128 v[152:155], v7 offset:8192
    ds_read_b128 v[156:159], v7 offset:12288
    ds_read_b128 v[176:179], v8 offset:8192
    ds_read_b128 v[180:183], v8 offset:12288
    ds_read_b128 v[184:187], v9 offset:8192
    ds_read_b128 v[188:191], v9 offset:12288
    s_waitcnt lgkmcnt(0)
    s_add_u32 m0, s93, 8192
    s_mov_b32 s55, 128
    buffer_load_dwordx4 v36, s[12:15], s55 offen offset:0 lds
    buffer_load_dwordx4 v37, s[12:15], s55 offen offset:1024 lds
    buffer_load_dwordx4 v38, s[12:15], s55 offen offset:2048 lds
    buffer_load_dwordx4 v39, s[12:15], s55 offen offset:3072 lds
    s_add_u32 m0, s93, 12288
    s_mov_b32 s55, 32896
    buffer_load_dwordx4 v36, s[12:15], s55 offen offset:0 lds
    buffer_load_dwordx4 v37, s[12:15], s55 offen offset:1024 lds
    buffer_load_dwordx4 v38, s[12:15], s55 offen offset:2048 lds
    buffer_load_dwordx4 v39, s[12:15], s55 offen offset:3072 lds
    s_lshr_b32 s95, s89, 3
    s_lshl_b32 s94, s88, 7
    s_lshl_b32 s95, s95, 6
    s_add_u32 s94, s94, s95
    s_lshr_b32 s95, s3, 2
    s_lshl_b32 s95, s95, 5
    s_add_u32 s94, s94, s95
    s_lshl_b32 s95, s90, 2
    s_add_u32 s94, s94, s95
    s_lshl_b32 s94, s94, 10
    s_and_b32 s95, s89, 7
    s_lshl_b32 s95, s95, 7
    v_and_b32 v20, 15, v0
    v_lshlrev_b32 v20, 3, v20
    v_add_u32 v20, s95, v20
    v_lshrrev_b32 v5, 4, v0
    v_lshl_add_u32 v5, v5, 10, v20
    v_add_u32 v5, s94, v5
    v_add_u32 v21, 0x4000, v5
    global_load_dwordx2 v[10:11], v5, s[36:37]
    global_load_dwordx2 v[12:13], v21, s[36:37]
    global_load_dwordx2 v[14:15], v20, s[52:53]
    s_waitcnt vmcnt(12)
    s_waitcnt lgkmcnt(7)
    ds_read_b128 v[192:195], v6 offset:0
    ds_read_b128 v[196:199], v6 offset:4096
    ds_read_b128 v[200:203], v7 offset:0
    ds_read_b128 v[204:207], v7 offset:4096
    ds_read_b128 v[224:227], v8 offset:0
    ds_read_b128 v[228:231], v8 offset:4096
    ds_read_b128 v[232:235], v9 offset:0
    ds_read_b128 v[236:239], v9 offset:4096
    v_mov_b32 v16, 0
    v_mov_b32 v17, 0
    s_mov_b64 exec, 0xff
    buffer_atomic_add_x2 v[16:17], v18, s[28:31], s17 offen sc0 sc1
    s_mov_b64 exec, -1
    s_waitcnt vmcnt(4)
    s_waitcnt lgkmcnt(7)
    ds_read_b128 v[208:211], v6 offset:8192
    ds_read_b128 v[212:215], v6 offset:12288
    ds_read_b128 v[216:219], v7 offset:8192
    ds_read_b128 v[220:223], v7 offset:12288
    ds_read_b128 v[240:243], v8 offset:8192
    ds_read_b128 v[244:247], v8 offset:12288
    ds_read_b128 v[248:251], v9 offset:8192
    ds_read_b128 v[252:255], v9 offset:12288
    s_waitcnt vmcnt(0)
    v_cmp_ne_u64 vcc, s[86:87], v[16:17]
    s_nop 0
    s_and_b64 vcc, vcc, 0xff
    s_cbranch_scc0 L_pd27
    s_mov_b32 s94, 20000
L_pl26:
    s_sleep 2
    v_mov_b32 v16, 0
    v_mov_b32 v17, 0
    s_mov_b64 exec, 0xff
    buffer_atomic_add_x2 v[16:17], v18, s[28:31], s17 offen sc0 sc1
    s_mov_b64 exec, -1
    s_sub_u32 s94, s94, 1
    s_waitcnt vmcnt(0)
    s_cbranch_scc1 L_pd27
    v_cmp_ne_u64 vcc, s[86:87], v[16:17]
    s_nop 0
    s_and_b64 vcc, vcc, 0xff
    s_cbranch_scc1 L_pl26
L_pd27:
    s_setprio 1
    buffer_load_dwordx4 v[16:19], v3, s[28:31], s70 offen offset:0 sc1
    buffer_load_dwordx4 v[20:23], v3, s[28:31], s71 offen offset:0 sc1
    buffer_load_dwordx4 v[24:27], v3, s[28:31], s70 offen offset:1024 sc1
    buffer_load_dwordx4 v[28:31], v3, s[28:31], s71 offen offset:1024 sc1
    buffer_load_dwordx4 v[32:35], v3, s[28:31], s70 offen offset:2304 sc1
    buffer_load_dwordx4 v[36:39], v3, s[28:31], s71 offen offset:2304 sc1
    buffer_load_dwordx4 v[40:43], v3, s[28:31], s70 offen offset:3328 sc1
    buffer_load_dwordx4 v[44:47], v3, s[28:31], s71 offen offset:3328 sc1
    s_waitcnt lgkmcnt(0)
    v_and_b32 v64, 31, v0
    v_lshlrev_b32 v6, 8, v64
    v_and_b32 v64, 7, v0
    v_lshrrev_b32 v65, 5, v0
    v_xor_b32 v64, v64, v65
    v_lshl_add_u32 v6, v64, 4, v6
    v_add_u32 v6, s93, v6
    v_xor_b32 v7, 32, v6
    v_xor_b32 v8, 64, v6
    v_xor_b32 v9, 96, v6
    s_waitcnt vmcnt(6)
    buffer_load_dwordx4 v[48:51], v3, s[28:31], s72 offen offset:0 sc1
    buffer_load_dwordx4 v[52:55], v3, s[28:31], s73 offen offset:0 sc1
    v_mfma_f32_32x32x16_bf16 v[64:79], v[128:131], v[16:19], 0
    v_mfma_f32_32x32x16_bf16 v[80:95], v[132:135], v[16:19], 0
    v_mfma_f32_32x32x16_bf16 v[96:111], v[128:131], v[20:23], 0
    v_mfma_f32_32x32x16_bf16 v[112:127], v[132:135], v[20:23], 0
    s_waitcnt vmcnt(6)
    buffer_load_dwordx4 v[56:59], v3, s[28:31], s72 offen offset:1024 sc1
    buffer_load_dwordx4 v[60:63], v3, s[28:31], s73 offen offset:1024 sc1
    v_mfma_f32_32x32x16_bf16 v[64:79], v[136:139], v[24:27], v[64:79]
    v_mfma_f32_32x32x16_bf16 v[80:95], v[140:143], v[24:27], v[80:95]
    v_mfma_f32_32x32x16_bf16 v[96:111], v[136:139], v[28:31], v[96:111]
    v_mfma_f32_32x32x16_bf16 v[112:127], v[140:143], v[28:31], v[112:127]
    s_waitcnt vmcnt(6)
    buffer_load_dwordx4 v[16:19], v3, s[28:31], s72 offen offset:2304 sc1
    buffer_load_dwordx4 v[20:23], v3, s[28:31], s73 offen offset:2304 sc1
    v_mfma_f32_32x32x16_bf16 v[64:79], v[144:147], v[32:35], v[64:79]
    v_mfma_f32_32x32x16_bf16 v[80:95], v[148:151], v[32:35], v[80:95]
    v_mfma_f32_32x32x16_bf16 v[96:111], v[144:147], v[36:39], v[96:111]
    v_mfma_f32_32x32x16_bf16 v[112:127], v[148:151], v[36:39], v[112:127]
    s_waitcnt vmcnt(6)
    buffer_load_dwordx4 v[24:27], v3, s[28:31], s72 offen offset:3328 sc1
    buffer_load_dwordx4 v[28:31], v3, s[28:31], s73 offen offset:3328 sc1
    v_mfma_f32_32x32x16_bf16 v[64:79], v[152:155], v[40:43], v[64:79]
    v_mfma_f32_32x32x16_bf16 v[80:95], v[156:159], v[40:43], v[80:95]
    v_mfma_f32_32x32x16_bf16 v[96:111], v[152:155], v[44:47], v[96:111]
    v_mfma_f32_32x32x16_bf16 v[112:127], v[156:159], v[44:47], v[112:127]
    s_waitcnt vmcnt(6)
    buffer_load_dwordx4 v[32:35], v3, s[28:31], s74 offen offset:0 sc1
    buffer_load_dwordx4 v[36:39], v3, s[28:31], s75 offen offset:0 sc1
    v_mfma_f32_32x32x16_bf16 v[64:79], v[160:163], v[48:51], v[64:79]
    v_mfma_f32_32x32x16_bf16 v[80:95], v[164:167], v[48:51], v[80:95]
    v_mfma_f32_32x32x16_bf16 v[96:111], v[160:163], v[52:55], v[96:111]
    v_mfma_f32_32x32x16_bf16 v[112:127], v[164:167], v[52:55], v[112:127]
    s_waitcnt vmcnt(6)
    buffer_load_dwordx4 v[40:43], v3, s[28:31], s74 offen offset:1024 sc1
    buffer_load_dwordx4 v[44:47], v3, s[28:31], s75 offen offset:1024 sc1
    v_mfma_f32_32x32x16_bf16 v[64:79], v[168:171], v[56:59], v[64:79]
    v_mfma_f32_32x32x16_bf16 v[80:95], v[172:175], v[56:59], v[80:95]
    v_mfma_f32_32x32x16_bf16 v[96:111], v[168:171], v[60:63], v[96:111]
    v_mfma_f32_32x32x16_bf16 v[112:127], v[172:175], v[60:63], v[112:127]
    s_waitcnt vmcnt(6)
    buffer_load_dwordx4 v[48:51], v3, s[28:31], s74 offen offset:2304 sc1
    buffer_load_dwordx4 v[52:55], v3, s[28:31], s75 offen offset:2304 sc1
    v_mfma_f32_32x32x16_bf16 v[64:79], v[176:179], v[16:19], v[64:79]
    v_mfma_f32_32x32x16_bf16 v[80:95], v[180:183], v[16:19], v[80:95]
    v_mfma_f32_32x32x16_bf16 v[96:111], v[176:179], v[20:23], v[96:111]
    v_mfma_f32_32x32x16_bf16 v[112:127], v[180:183], v[20:23], v[112:127]
    s_waitcnt vmcnt(6)
    buffer_load_dwordx4 v[56:59], v3, s[28:31], s74 offen offset:3328 sc1
    buffer_load_dwordx4 v[60:63], v3, s[28:31], s75 offen offset:3328 sc1
    v_mfma_f32_32x32x16_bf16 v[64:79], v[184:187], v[24:27], v[64:79]
    v_mfma_f32_32x32x16_bf16 v[80:95], v[188:191], v[24:27], v[80:95]
    v_mfma_f32_32x32x16_bf16 v[96:111], v[184:187], v[28:31], v[96:111]
    v_mfma_f32_32x32x16_bf16 v[112:127], v[188:191], v[28:31], v[112:127]
    s_waitcnt vmcnt(6)
    buffer_load_dwordx4 v[16:19], v3, s[28:31], s76 offen offset:0 sc1
    buffer_load_dwordx4 v[20:23], v3, s[28:31], s77 offen offset:0 sc1
    v_mfma_f32_32x32x16_bf16 v[64:79], v[192:195], v[32:35], v[64:79]
    v_mfma_f32_32x32x16_bf16 v[80:95], v[196:199], v[32:35], v[80:95]
    v_mfma_f32_32x32x16_bf16 v[96:111], v[192:195], v[36:39], v[96:111]
    v_mfma_f32_32x32x16_bf16 v[112:127], v[196:199], v[36:39], v[112:127]
    s_waitcnt vmcnt(6)
    buffer_load_dwordx4 v[24:27], v3, s[28:31], s76 offen offset:1024 sc1
    buffer_load_dwordx4 v[28:31], v3, s[28:31], s77 offen offset:1024 sc1
    v_mfma_f32_32x32x16_bf16 v[64:79], v[200:203], v[40:43], v[64:79]
    v_mfma_f32_32x32x16_bf16 v[80:95], v[204:207], v[40:43], v[80:95]
    v_mfma_f32_32x32x16_bf16 v[96:111], v[200:203], v[44:47], v[96:111]
    v_mfma_f32_32x32x16_bf16 v[112:127], v[204:207], v[44:47], v[112:127]
    s_waitcnt vmcnt(6)
    buffer_load_dwordx4 v[32:35], v3, s[28:31], s76 offen offset:2304 sc1
    buffer_load_dwordx4 v[36:39], v3, s[28:31], s77 offen offset:2304 sc1
    v_mfma_f32_32x32x16_bf16 v[64:79], v[208:211], v[48:51], v[64:79]
    v_mfma_f32_32x32x16_bf16 v[80:95], v[212:215], v[48:51], v[80:95]
    v_mfma_f32_32x32x16_bf16 v[96:111], v[208:211], v[52:55], v[96:111]
    v_mfma_f32_32x32x16_bf16 v[112:127], v[212:215], v[52:55], v[112:127]
    s_waitcnt vmcnt(6)
    buffer_load_dwordx4 v[40:43], v3, s[28:31], s76 offen offset:3328 sc1
    buffer_load_dwordx4 v[44:47], v3, s[28:31], s77 offen offset:3328 sc1
    v_mfma_f32_32x32x16_bf16 v[64:79], v[216:219], v[56:59], v[64:79]
    v_mfma_f32_32x32x16_bf16 v[80:95], v[220:223], v[56:59], v[80:95]
    v_mfma_f32_32x32x16_bf16 v[96:111], v[216:219], v[60:63], v[96:111]
    v_mfma_f32_32x32x16_bf16 v[112:127], v[220:223], v[60:63], v[112:127]
    s_waitcnt vmcnt(6)
    v_mfma_f32_32x32x16_bf16 v[64:79], v[224:227], v[16:19], v[64:79]
    v_mfma_f32_32x32x16_bf16 v[80:95], v[228:231], v[16:19], v[80:95]
    v_mfma_f32_32x32x16_bf16 v[96:111], v[224:227], v[20:23], v[96:111]
    v_mfma_f32_32x32x16_bf16 v[112:127], v[228:231], v[20:23], v[112:127]
    s_waitcnt vmcnt(4)
    v_mfma_f32_32x32x16_bf16 v[64:79], v[232:235], v[24:27], v[64:79]
    v_mfma_f32_32x32x16_bf16 v[80:95], v[236:239], v[24:27], v[80:95]
    v_mfma_f32_32x32x16_bf16 v[96:111], v[232:235], v[28:31], v[96:111]
    v_mfma_f32_32x32x16_bf16 v[112:127], v[236:239], v[28:31], v[112:127]
    s_waitcnt vmcnt(2)
    v_mfma_f32_32x32x16_bf16 v[64:79], v[240:243], v[32:35], v[64:79]
    v_mfma_f32_32x32x16_bf16 v[80:95], v[244:247], v[32:35], v[80:95]
    v_mfma_f32_32x32x16_bf16 v[96:111], v[240:243], v[36:39], v[96:111]
    v_mfma_f32_32x32x16_bf16 v[112:127], v[244:247], v[36:39], v[112:127]
    s_waitcnt vmcnt(0)
    v_mfma_f32_32x32x16_bf16 v[64:79], v[248:251], v[40:43], v[64:79]
    v_mfma_f32_32x32x16_bf16 v[80:95], v[252:255], v[40:43], v[80:95]
    v_mfma_f32_32x32x16_bf16 v[96:111], v[248:251], v[44:47], v[96:111]
    v_mfma_f32_32x32x16_bf16 v[112:127], v[252:255], v[44:47], v[112:127]
    s_nop 8
    ds_write_b128 v6, v[64:67] offset:0
    ds_write_b128 v7, v[68:71] offset:0
    ds_write_b128 v8, v[72:75] offset:0
    ds_write_b128 v9, v[76:79] offset:0
    ds_write_b128 v6, v[80:83] offset:128
    ds_write_b128 v7, v[84:87] offset:128
    ds_write_b128 v8, v[88:91] offset:128
    ds_write_b128 v9, v[92:95] offset:128
    ds_write_b128 v6, v[96:99] offset:8192
    ds_write_b128 v7, v[100:103] offset:8192
    ds_write_b128 v8, v[104:107] offset:8192
    ds_write_b128 v9, v[108:111] offset:8192
    ds_write_b128 v6, v[112:115] offset:8320
    ds_write_b128 v7, v[116:119] offset:8320
    ds_write_b128 v8, v[120:123] offset:8320
    ds_write_b128 v9, v[124:127] offset:8320
    s_mov_b32 s32, s64
    s_mov_b32 s33, s65
    s_mov_b32 s34, 4194304
    s_mov_b32 s35, 0x20000
    v_lshrrev_b32 v16, 4, v0
    v_and_b32 v17, 15, v0
    v_xor_b32 v17, v17, v16
    v_lshlrev_b32 v17, 4, v17
    v_lshl_add_u32 v17, v16, 8, v17
    s_lshl_b32 s94, s3, 11
    v_add_u32 v17, s94, v17
    v_xor_b32 v18, 64, v17
    v_add_u32 v19, 65536, v17
    v_add_u32 v20, 65536, v18
    s_lshl_b32 s94, s3, 5
    s_add_u32 s94, s94, 131584
    v_lshl_add_u32 v16, v16, 2, s94
    v_lshlrev_b32 v5, 1, v5
    v_lshlrev_b32 v30, 16, v14
    v_and_b32 v31, 0xffff0000, v14
    v_lshlrev_b32 v22, 16, v10
    v_and_b32 v23, 0xffff0000, v10
    v_mul_f32 v22, v22, v30
    v_mul_f32 v23, v23, v31
    v_lshlrev_b32 v26, 16, v12
    v_and_b32 v27, 0xffff0000, v12
    v_mul_f32 v26, v26, v30
    v_mul_f32 v27, v27, v31
    v_lshlrev_b32 v30, 16, v15
    v_and_b32 v31, 0xffff0000, v15
    v_lshlrev_b32 v24, 16, v11
    v_and_b32 v25, 0xffff0000, v11
    v_mul_f32 v24, v24, v30
    v_mul_f32 v25, v25, v31
    v_lshlrev_b32 v28, 16, v13
    v_and_b32 v29, 0xffff0000, v13
    v_mul_f32 v28, v28, v30
    v_mul_f32 v29, v29, v31
L_final:
    s_waitcnt lgkmcnt(0)
    s_barrier
    ds_read_b32 v30, v16
    ds_read_b32 v36, v16 offset:16
    ds_read_b128 v[40:43], v17 offset:0
    ds_read_b128 v[44:47], v17 offset:16384
    ds_read_b128 v[48:51], v17 offset:32768
    ds_read_b128 v[52:55], v17 offset:49152
    ds_read_b128 v[56:59], v19 offset:0
    ds_read_b128 v[60:63], v19 offset:16384
    ds_read_b128 v[64:67], v18 offset:1024
    ds_read_b128 v[68:71], v18 offset:17408
    ds_read_b128 v[72:75], v18 offset:33792
    ds_read_b128 v[76:79], v18 offset:50176
    ds_read_b128 v[80:83], v20 offset:1024
    ds_read_b128 v[84:87], v20 offset:17408
    s_mov_b32 s94, 0x8000
    s_waitcnt lgkmcnt(6)
    v_pk_add_f32 v[40:41], v[22:23], v[40:41]
    v_pk_add_f32 v[44:45], v[44:45], v[48:49]
    v_pk_add_f32 v[56:57], v[56:57], v[60:61]
    v_pk_add_f32 v[40:41], v[40:41], v[52:53]
    v_pk_add_f32 v[44:45], v[44:45], v[56:57] neg_lo:[0,1] neg_hi:[0,1]
    v_pk_add_f32 v[40:41], v[40:41], v[44:45]
    v_pk_fma_f32 v[40:41], v[40:41], v[30:31], v[56:57] op_sel_hi:[1,0,1]
    v_pk_add_f32 v[42:43], v[24:25], v[42:43]
    v_pk_add_f32 v[46:47], v[46:47], v[50:51]
    v_pk_add_f32 v[58:59], v[58:59], v[62:63]
    v_pk_add_f32 v[42:43], v[42:43], v[54:55]
    v_pk_add_f32 v[46:47], v[46:47], v[58:59] neg_lo:[0,1] neg_hi:[0,1]
    v_pk_add_f32 v[42:43], v[42:43], v[46:47]
    v_pk_fma_f32 v[42:43], v[42:43], v[30:31], v[58:59] op_sel_hi:[1,0,1]
    buffer_store_dwordx4 v[40:43], v5, s[32:35], 0 offen sc1
    s_waitcnt lgkmcnt(0)
    v_pk_add_f32 v[64:65], v[26:27], v[64:65]
    v_pk_add_f32 v[68:69], v[68:69], v[72:73]
    v_pk_add_f32 v[80:81], v[80:81], v[84:85]
    v_pk_add_f32 v[64:65], v[64:65], v[76:77]
    v_pk_add_f32 v[68:69], v[68:69], v[80:81] neg_lo:[0,1] neg_hi:[0,1]
    v_pk_add_f32 v[64:65], v[64:65], v[68:69]
    v_pk_fma_f32 v[64:65], v[64:65], v[36:37], v[80:81] op_sel_hi:[1,0,1]
    v_pk_add_f32 v[66:67], v[28:29], v[66:67]
    v_pk_add_f32 v[70:71], v[70:71], v[74:75]
    v_pk_add_f32 v[82:83], v[82:83], v[86:87]
    v_pk_add_f32 v[66:67], v[66:67], v[78:79]
    v_pk_add_f32 v[70:71], v[70:71], v[82:83] neg_lo:[0,1] neg_hi:[0,1]
    v_pk_add_f32 v[66:67], v[66:67], v[70:71]
    v_pk_fma_f32 v[66:67], v[66:67], v[36:37], v[82:83] op_sel_hi:[1,0,1]
    buffer_store_dwordx4 v[64:67], v5, s[32:35], s94 offen sc1
    s_or_b32 s94, s88, s89
    s_or_b32 s94, s94, s3
    s_cbranch_scc1 L_f1
    v_mov_b32 v16, s86
    s_mov_b64 exec, 1
    buffer_store_dword v16, off, s[28:31], 0 offset:0 sc1
    s_mov_b64 exec, -1
L_f1:
L_end:
    s_endpgm
L_role_coldS:
    s_endpgm
L_codeend:
.section .rodata,"a"
.p2align 6
.amdhsa_kernel gated_mix__ssm_conv_s5__linear_kernel_hedgehog__prompt_kernel
  .amdhsa_next_free_vgpr 256
  .amdhsa_next_free_sgpr 102
  .amdhsa_accum_offset 256
  .amdhsa_group_segment_fixed_size 0
  .amdhsa_kernarg_size 136
  .amdhsa_user_sgpr_count 2
  .amdhsa_user_sgpr_kernarg_segment_ptr 1
  .amdhsa_system_sgpr_workgroup_id_x 1
.end_amdhsa_kernel
```
